```python
import torch

def _softmax(x, axis=-1):
    return torch.softmax(x, dim=axis)
def _gelu(x):
    return torch.nn.functional.gelu(x, approximate="tanh")
def _silu(x):
    return torch.nn.functional.silu(x)
def _sigmoid(x):
    return torch.sigmoid(x)
def _layernorm(x, axis=-1, eps=1e-5):
    m = x.mean(dim=axis, keepdim=True)
    v = x.var(dim=axis, keepdim=True, unbiased=False)
    return (x - m) / torch.sqrt(v + eps)
def _scatter_add(tgt, idx, src, axis=0):
    return tgt.clone().index_add_(axis, idx, src)
def _segment_sum(src, seg, n):
    out = torch.zeros((n,) + src.shape[1:], dtype=src.dtype)
    return out.index_add_(0, seg, src)
def _pad(x, pw):
    flat = tuple(v for pair in reversed(pw) for v in pair)
    return torch.nn.functional.pad(x, flat)

kernel_name = 'recurrent_scan__ssm_conv_s5__glu_gated_reglu__prompt'

def setup_inputs():

    _w = (lambda a: (lambda t: t.to(torch.bfloat16) if t.is_floating_point() else t)(torch.as_tensor(a)))
    def _A_setup():
        B, S, D = 1, 2048, 448
        P = D
        Lambda_re = -0.5 * (lambda _x: torch.exp(torch.as_tensor(_x)))((lambda *s: torch.randn(*s, dtype=torch.bfloat16) * 0.8)(P))
        Lambda_im = (lambda *s: torch.randn(*s, dtype=torch.bfloat16) * 0.8)(P) * 1.0
        B_re = (lambda *s: torch.randn(*s, dtype=torch.bfloat16) * 0.8)(P, D) * (D ** -0.5)
        B_im = (lambda *s: torch.randn(*s, dtype=torch.bfloat16) * 0.8)(P, D) * (D ** -0.5)
        C_re = (lambda *s: torch.randn(*s, dtype=torch.bfloat16) * 0.8)(D, P) * (P ** -0.5)
        C_im = (lambda *s: torch.randn(*s, dtype=torch.bfloat16) * 0.8)(D, P) * (P ** -0.5)
        log_dt = (lambda *s: torch.randn(*s, dtype=torch.bfloat16) * 0.8)(P) * 0.3 - 2.0
        Dskip = (lambda *s: torch.randn(*s, dtype=torch.bfloat16) * 0.8)(D)
        return {
            "x": _w((lambda *s: torch.randn(*s, dtype=torch.bfloat16) * 0.05)(B, S, D)),
            "Lambda_re": _w(Lambda_re),
            "Lambda_im": _w(Lambda_im),
            "B_re": _w(B_re),
            "B_im": _w(B_im),
            "C_re": _w(C_re),
            "C_im": _w(C_im),
            "log_dt": _w(log_dt),
            "Dskip": _w(Dskip),
        }
    _A_in = _A_setup()

    def _B_setup():
        B, S, D, F = 1, 2048, 448, 1792
        return {
            "x": _w((lambda *s: torch.randn(*s, dtype=torch.bfloat16) * 0.05)(B, S, D)),
            "W_gate": _w((lambda *s: torch.randn(*s, dtype=torch.bfloat16) * 0.2)(D, F) * (2.0 / D) ** 0.5),
            "W_up": _w((lambda *s: torch.randn(*s, dtype=torch.bfloat16) * 0.2)(D, F) * (2.0 / D) ** 0.5),
            "W_down": _w((lambda *s: torch.randn(*s, dtype=torch.bfloat16) * 0.2)(F, D) * (1.0 / F) ** 0.5),
        }
    _B_in = _B_setup()

    return {
        "A_x": _A_in["x"],
        "A_Lambda_re": _A_in["Lambda_re"],
        "A_Lambda_im": _A_in["Lambda_im"],
        "A_B_re": _A_in["B_re"],
        "A_B_im": _A_in["B_im"],
        "A_C_re": _A_in["C_re"],
        "A_C_im": _A_in["C_im"],
        "A_log_dt": _A_in["log_dt"],
        "A_Dskip": _A_in["Dskip"],
        "B_x": _B_in["x"],
        "B_W_gate": _B_in["W_gate"],
        "B_W_up": _B_in["W_up"],
        "B_W_down": _B_in["W_down"],
    }

def reference(A_x, A_Lambda_re, A_Lambda_im, A_B_re, A_B_im, A_C_re, A_C_im, A_log_dt, A_Dskip, B_x, B_W_gate, B_W_up, B_W_down):
    def _A_ref(x, Lambda_re, Lambda_im, B_re, B_im, C_re, C_im, log_dt, Dskip):
        Bsz, L, H = x.shape
        Lam = Lambda_re + 1j * Lambda_im
        Bmat = B_re + 1j * B_im
        Cmat = C_re + 1j * C_im
        dt = torch.exp(log_dt)
        Lam_bar = torch.exp(dt * Lam)
        B_bar = ((Lam_bar - 1.0) / Lam)[:, None] * Bmat
        Bu = torch.einsum("bld,pd->blp", x + 0j, B_bar)
        h = torch.zeros_like(Bu[:, 0, :])
        hs = []
        for t in range(L):
            h = Lam_bar[None, :] * h + Bu[:, t, :]
            hs.append(h)
        hseq = torch.stack(hs, 1)
        y = 2.0 * torch.einsum("blp,dp->bld", hseq, Cmat).real + x * Dskip[None, None, :]
        return y

    def _B_ref(x, W_gate, W_up, W_down):
        gate = torch.einsum("bsd,df->bsf", x, W_gate)
        up = torch.einsum("bsd,df->bsf", x, W_up)
        gate = gate * (lambda x, dt: x.to(dt))(gate > 0, gate.dtype)
        h = gate * up
        return torch.einsum("bsf,fd->bsd", h, W_down)

    x = A_x
    xn = _layernorm(x, axis=-1)
    s = _A_ref(xn, A_Lambda_re, A_Lambda_im, A_B_re, A_B_im, A_C_re, A_C_im, A_log_dt, A_Dskip)
    g = _silu(_B_ref(xn, B_W_gate, B_W_up, B_W_down))
    return x + s * g
```

```asm
; @launch grid=(252,1,1) block=(512,1,1) lds=163840
.amdgcn_target "amdgcn-amd-amdhsa--gfx950"
.text
.globl recurrent_scan__ssm_conv_s5__glu_gated_reglu__prompt_kernel
.p2align 8
.type recurrent_scan__ssm_conv_s5__glu_gated_reglu__prompt_kernel,@function
recurrent_scan__ssm_conv_s5__glu_gated_reglu__prompt_kernel:
    s_load_dwordx16 s[32:47], s[0:1], 0
    s_load_dwordx16 s[48:63], s[0:1], 64
    v_readfirstlane_b32 s3, v0
    s_cmpk_lt_u32 s2, 224
    s_cbranch_scc1 K_MAIN
    s_cmpk_lt_u32 s2, 244
    s_cbranch_scc1 K_SPARE
    s_getpc_b64 s[28:29]
K_PC:
    v_lshlrev_b32 v7, 7, v0
    v_min_u32 v7, ALL_END-K_PC-4, v7
    global_load_dword v83, v7, s[28:29]
    s_branch K_SPARE
K_MAIN:
    v_and_b32 v0, 63, v0
    s_lshr_b32 s3, s3, 6
    s_and_b32 s4, s3, 3
    s_and_b32 s5, s2, 3
    s_lshl_b32 s5, s5, 2
    s_bfe_u32 s99, s2, 0x20003
    s_add_u32 s5, s5, s99
    s_lshr_b32 s91, s2, 5
    v_lshrrev_b32 v21, 5, v0
    s_lshl_b32 s89, s4, 12
    s_cmp_ge_u32 s3, 4
    s_cbranch_scc1 K_S
    v_bfe_u32 v6, v0, 3, 2
    v_and_b32 v9, 7, v0
    v_lshrrev_b32 v7, 4, v0
    v_xor_b32 v9, v9, v7
    v_lshlrev_b32 v9, 4, v9
    v_xor_b32 v7, 64, v9
    v_lshl_add_u32 v5, v21, 4, v6
    s_movk_i32 s30, 0x380
    v_mad_u32_u24 v1, v5, s30, v9
    v_mad_u32_u24 v2, v5, s30, v7
    s_movk_i32 s31, 2560
    v_add_u32 v2, s31, v2
    s_lshr_b32 s7, s2, 6
    s_and_b32 s10, s2, 3
    s_sub_u32 s7, s7, s10
    s_cselect_b32 s10, 7, 0
    s_add_u32 s7, s7, s10
    s_lshl_b32 s64, s7, 7
    s_lshl_b32 s28, s5, 2
    s_add_u32 s28, s28, s4
    s_mulk_i32 s28, 28672
    s_lshl_b32 s31, s31, 1
    v_add_u32 v3, s31, v1
    v_add_u32 v4, s31, v2
    s_mov_b32 s10, 1835008
    s_mov_b32 s11, 0x20000
    s_mov_b32 m0, s89
    s_add_u32 s83, s28, s64
    s_waitcnt lgkmcnt(0)
    s_mov_b32 s8, s32
    s_and_b32 s9, s33, 0xffff
    buffer_load_dwordx4 v1, s[8:11], s83 offen lds
    buffer_load_dwordx4 v2, s[8:11], s83 offen offset:1024 lds
    buffer_load_dwordx4 v3, s[8:11], s83 offen offset:2048 lds
    buffer_load_dwordx4 v4, s[8:11], s83 offen offset:3072 lds
    s_bfe_u32 s85, s2, 0x10002
    s_mul_i32 s6, s85, 7
    s_add_u32 s6, s6, s91
    s_lshl_b32 s79, s4, 11
    s_add_u32 s79, s79, 114688
    v_lshl_add_u32 v6, v21, 3, v6
    v_mad_u32_u24 v5, v6, s30, v9
    v_mad_u32_u24 v6, v6, s30, v7
    v_add_u32 v6, 2560, v6
    s_lshl_b32 s29, s6, 1
    s_and_b32 s30, s4, 1
    s_add_u32 s29, s29, s30
    s_mulk_i32 s29, 14336
    s_cmp_lt_u32 s4, 2
    s_cselect_b32 s12, s38, s40
    s_cselect_b32 s13, s39, s41
    s_and_b32 s13, s13, 0xffff
    s_mov_b32 s14, 401408
    s_mov_b32 s15, 0x20000
    s_mov_b32 m0, s79
    s_add_u32 s83, s29, s64
    buffer_load_dwordx4 v5, s[12:15], s83 offen lds
    buffer_load_dwordx4 v6, s[12:15], s83 offen offset:1024 lds
    s_setprio 2
    s_add_u32 s65, s64, 128
    s_cmp_ge_u32 s65, 896
    s_cselect_b32 s65, 0, s65
    s_add_u32 s66, s65, 128
    s_cmp_ge_u32 s66, 896
    s_cselect_b32 s66, 0, s66
    s_add_u32 s67, s66, 128
    s_cmp_ge_u32 s67, 896
    s_cselect_b32 s67, 0, s67
    s_add_u32 s68, s67, 128
    s_cmp_ge_u32 s68, 896
    s_cselect_b32 s68, 0, s68
    s_add_u32 s69, s68, 128
    s_cmp_ge_u32 s69, 896
    s_cselect_b32 s69, 0, s69
    s_add_u32 s70, s69, 128
    s_cmp_ge_u32 s70, 896
    s_cselect_b32 s70, 0, s70
    s_add_u32 m0, s89, 16384
    s_add_u32 s83, s28, s65
    buffer_load_dwordx4 v1, s[8:11], s83 offen lds
    buffer_load_dwordx4 v2, s[8:11], s83 offen offset:1024 lds
    buffer_load_dwordx4 v3, s[8:11], s83 offen offset:2048 lds
    buffer_load_dwordx4 v4, s[8:11], s83 offen offset:3072 lds
    s_add_u32 m0, s79, 8192
    s_add_u32 s83, s29, s65
    buffer_load_dwordx4 v5, s[12:15], s83 offen lds
    buffer_load_dwordx4 v6, s[12:15], s83 offen offset:1024 lds
    s_mov_b32 s20, s62
    s_and_b32 s21, s63, 0xffff
    s_mov_b32 s22, 18591872
    s_mov_b32 s23, 0x20000
    v_mov_b32 v120, 0
    s_mov_b32 s82, 18591744
    s_mov_b32 s82, 18591744
    s_mov_b64 exec, 1
    buffer_load_dword v120, v120, s[20:23], s82 offen sc1
    s_mov_b64 exec, -1
    v_mov_b32 v124, 0
    v_mov_b32 v125, 0
    s_lshl_b32 s31, s4, 9
    s_add_u32 s31, s31, 158720
    v_lshl_add_u32 v8, v0, 3, s31
    ds_write_b64 v8, v[124:125]
    v_lshlrev_b32 v8, 2, v0
    v_add_u32 v8, 162816, v8
    ds_write_b32 v8, v124
    v_lshrrev_b32 v23, 4, v0
    v_and_b32 v20, 15, v0
    v_bfe_u32 v10, v0, 1, 3
    v_xor_b32 v10, v10, v23
    v_lshlrev_b32 v10, 4, v10
    v_lshl_add_u32 v10, v20, 7, v10
    v_xor_b32 v11, 64, v10
    v_add_u32 v12, 0x10000, v10
    v_add_u32 v13, 0x10000, v11
    s_mov_b32 s16, s52
    s_and_b32 s17, s53, 0xffff
    s_mov_b32 s18, 1605632
    s_mov_b32 s19, 0x20000
    s_mov_b32 s24, s54
    s_and_b32 s25, s55, 0xffff
    s_mov_b32 s26, 1605632
    s_mov_b32 s27, 0x20000
    s_lshl_b32 s31, s6, 8
    s_lshl_b32 s82, s4, 6
    s_add_u32 s31, s31, s82
    s_mul_i32 s72, s64, 1792
    s_add_u32 s72, s72, s31
    s_mul_i32 s73, s65, 1792
    s_add_u32 s73, s73, s31
    s_mul_i32 s74, s66, 1792
    s_add_u32 s74, s74, s31
    s_mul_i32 s75, s67, 1792
    s_add_u32 s75, s75, s31
    s_mul_i32 s76, s68, 1792
    s_add_u32 s76, s76, s31
    s_mul_i32 s77, s69, 1792
    s_add_u32 s77, s77, s31
    s_mul_i32 s78, s70, 1792
    s_add_u32 s78, s78, s31
    v_bfe_u32 v8, v0, 2, 2
    v_lshl_add_u32 v7, v23, 3, v8
    v_mul_u32_u24 v7, 0xe00, v7
    v_and_b32 v22, 1, v23
    v_lshlrev_b32 v9, 1, v22
    v_and_b32 v14, 3, v0
    v_xor_b32 v9, v9, v14
    v_lshl_add_u32 v7, v9, 4, v7
    v_lshrrev_b32 v9, 2, v0
    v_lshlrev_b32 v9, 6, v9
    v_lshl_add_u32 v9, v22, 5, v9
    v_lshl_add_u32 v9, v14, 3, v9
    v_add_u32 v125, s89, v9
    v_add_u32 v9, s79, v9
    v_xor_b32 v14, 32, v9
    v_xor_b32 v15, 32, v125
    v_lshlrev_b32 v18, 4, v0
    s_lshl_b32 s31, s4, 2
    s_add_u32 s31, s31, 162816
    v_mov_b32 v19, s31
    s_lshl_b32 s31, s4, 8
    s_add_u32 s31, s31, 157696
    v_lshl_add_u32 v122, v23, 4, s31
    v_bfe_u32 v123, v0, 2, 1
    v_lshlrev_b32 v123, 4, v123
    v_bfe_u32 v8, v0, 3, 1
    v_lshl_add_u32 v123, v8, 2, v123
    v_and_b32 v8, 3, v0
    v_add_u32 v123, v123, v8
    v_lshlrev_b32 v123, 2, v123
    v_add_u32 v123, 155648, v123
    v_lshlrev_b32 v17, 2, v8
    v_add_u32 v17, 162816, v17
    v_mov_b32 v8, 162816
    s_lshl_b32 s92, s5, 2
    s_add_u32 s92, s92, s4
    s_mul_i32 s92, s92, 114688
    s_add_u32 s92, s92, 3670016
    s_lshl_b32 s31, s6, 13
    s_add_u32 s86, s92, s31
    s_add_u32 s87, s86, 4096
    s_add_u32 m0, s89, 32768
    s_add_u32 s83, s28, s66
    buffer_load_dwordx4 v1, s[8:11], s83 offen lds
    buffer_load_dwordx4 v2, s[8:11], s83 offen offset:1024 lds
    buffer_load_dwordx4 v3, s[8:11], s83 offen offset:2048 lds
    buffer_load_dwordx4 v4, s[8:11], s83 offen offset:3072 lds
    s_add_u32 m0, s79, 16384
    s_add_u32 s83, s29, s66
    buffer_load_dwordx4 v5, s[12:15], s83 offen lds
    buffer_load_dwordx4 v6, s[12:15], s83 offen offset:1024 lds
    s_waitcnt vmcnt(13)
    s_waitcnt lgkmcnt(0)
    s_barrier
    s_add_u32 m0, s89, 49152
    s_add_u32 s83, s28, s67
    buffer_load_dwordx4 v1, s[8:11], s83 offen lds
    buffer_load_dwordx4 v2, s[8:11], s83 offen offset:1024 lds
    buffer_load_dwordx4 v3, s[8:11], s83 offen offset:2048 lds
    buffer_load_dwordx4 v4, s[8:11], s83 offen offset:3072 lds
    s_add_u32 m0, s79, 24576
    s_add_u32 s83, s29, s67
    buffer_load_dwordx4 v5, s[12:15], s83 offen lds
    buffer_load_dwordx4 v6, s[12:15], s83 offen offset:1024 lds
    s_waitcnt vmcnt(12)
    s_barrier
    s_add_u32 m0, s89, 65536
    s_add_u32 s83, s28, s68
    buffer_load_dwordx4 v1, s[8:11], s83 offen lds
    buffer_load_dwordx4 v2, s[8:11], s83 offen offset:1024 lds
    buffer_load_dwordx4 v3, s[8:11], s83 offen offset:2048 lds
    buffer_load_dwordx4 v4, s[8:11], s83 offen offset:3072 lds
    s_add_u32 m0, s79, 32768
    s_add_u32 s83, s29, s68
    buffer_load_dwordx4 v5, s[12:15], s83 offen lds
    buffer_load_dwordx4 v6, s[12:15], s83 offen offset:1024 lds
    v_readfirstlane_b32 s84, v120
    s_add_u32 s84, s84, 1
    s_max_u32 s84, s84, 1
    s_waitcnt vmcnt(12)
    s_barrier
    s_add_u32 m0, s89, 81920
    s_add_u32 s83, s28, s69
    buffer_load_dwordx4 v1, s[8:11], s83 offen lds
    buffer_load_dwordx4 v2, s[8:11], s83 offen offset:1024 lds
    buffer_load_dwordx4 v3, s[8:11], s83 offen offset:2048 lds
    buffer_load_dwordx4 v4, s[8:11], s83 offen offset:3072 lds
    s_add_u32 m0, s79, 0
    s_add_u32 s83, s29, s69
    buffer_load_dwordx4 v5, s[12:15], s83 offen lds
    buffer_load_dwordx4 v6, s[12:15], s83 offen offset:1024 lds
    s_waitcnt vmcnt(12)
    s_barrier
    s_add_u32 m0, s89, 98304
    s_add_u32 s83, s28, s70
    buffer_load_dwordx4 v1, s[8:11], s83 offen lds
    buffer_load_dwordx4 v2, s[8:11], s83 offen offset:1024 lds
    buffer_load_dwordx4 v3, s[8:11], s83 offen offset:2048 lds
    buffer_load_dwordx4 v4, s[8:11], s83 offen offset:3072 lds
    s_add_u32 m0, s79, 8192
    s_add_u32 s83, s29, s70
    buffer_load_dwordx4 v5, s[12:15], s83 offen lds
    buffer_load_dwordx4 v6, s[12:15], s83 offen offset:1024 lds
    s_add_u32 m0, s79, 16384
    s_add_u32 s83, s72, 0
    buffer_load_dwordx4 v7, s[16:19], s83 offen lds
    s_add_u32 m0, s79, 17408
    s_add_u32 s83, s72, 0
    buffer_load_dwordx4 v7, s[24:27], s83 offen lds
    s_waitcnt vmcnt(14)
    s_barrier
    s_add_u32 m0, s79, 24576
    s_add_u32 s83, s72, 14336
    buffer_load_dwordx4 v7, s[16:19], s83 offen lds
    s_add_u32 m0, s79, 25600
    s_add_u32 s83, s72, 14336
    buffer_load_dwordx4 v7, s[24:27], s83 offen lds
    s_waitcnt vmcnt(10)
    s_barrier
    s_add_u32 m0, s79, 32768
    s_add_u32 s83, s72, 114688
    buffer_load_dwordx4 v7, s[16:19], s83 offen lds
    s_add_u32 m0, s79, 33792
    s_add_u32 s83, s72, 114688
    buffer_load_dwordx4 v7, s[24:27], s83 offen lds
    v_lshrrev_b32 v2, 3, v0
    v_mul_u32_u24 v2, 0x380, v2
    v_lshrrev_b32 v3, 4, v0
    v_lshlrev_b32 v3, 1, v3
    v_and_b32 v1, 7, v0
    v_xor_b32 v1, v1, v3
    v_lshl_add_u32 v2, v1, 4, v2
    v_add_u32 v3, 6144, v2
    s_mov_b32 s12, s56
    s_and_b32 s13, s57, 0xffff
    s_mov_b32 s14, 1605632
    s_mov_b32 s15, 0x20000
    s_lshl_b32 s98, s99, 1
    s_mul_i32 s88, s4, 28672
    s_lshl_b32 s82, s91, 7
    s_add_u32 s88, s88, s82
    s_mul_i32 s82, s85, 802816
    s_add_u32 s88, s88, s82
    s_mul_i32 s64, s91, 114688
    s_add_u32 s64, s64, s88
    s_cmp_eq_u32 s98, s91
    s_addc_u32 s98, s98, 0
    s_cmp_ge_u32 s98, 7
    s_cselect_b32 s98, 0, s98
    s_lshl_b32 s46, s98, 13
    s_mul_i32 s65, s98, 114688
    s_add_u32 s65, s65, s88
    s_add_u32 s98, s98, 1
    s_cmp_ge_u32 s98, 7
    s_cselect_b32 s98, 0, s98
    s_cmp_eq_u32 s98, s91
    s_addc_u32 s98, s98, 0
    s_cmp_ge_u32 s98, 7
    s_cselect_b32 s98, 0, s98
    s_lshl_b32 s47, s98, 13
    s_mul_i32 s66, s98, 114688
    s_add_u32 s66, s66, s88
    s_add_u32 s98, s98, 1
    s_cmp_ge_u32 s98, 7
    s_cselect_b32 s98, 0, s98
    s_cmp_eq_u32 s98, s91
    s_addc_u32 s98, s98, 0
    s_cmp_ge_u32 s98, 7
    s_cselect_b32 s98, 0, s98
    s_lshl_b32 s48, s98, 13
    s_mul_i32 s67, s98, 114688
    s_add_u32 s67, s67, s88
    s_add_u32 s98, s98, 1
    s_cmp_ge_u32 s98, 7
    s_cselect_b32 s98, 0, s98
    s_cmp_eq_u32 s98, s91
    s_addc_u32 s98, s98, 0
    s_cmp_ge_u32 s98, 7
    s_cselect_b32 s98, 0, s98
    s_lshl_b32 s49, s98, 13
    s_mul_i32 s68, s98, 114688
    s_add_u32 s68, s68, s88
    s_add_u32 s98, s98, 1
    s_cmp_ge_u32 s98, 7
    s_cselect_b32 s98, 0, s98
    s_cmp_eq_u32 s98, s91
    s_addc_u32 s98, s98, 0
    s_cmp_ge_u32 s98, 7
    s_cselect_b32 s98, 0, s98
    s_lshl_b32 s50, s98, 13
    s_mul_i32 s69, s98, 114688
    s_add_u32 s69, s69, s88
    s_add_u32 s98, s98, 1
    s_cmp_ge_u32 s98, 7
    s_cselect_b32 s98, 0, s98
    s_cmp_eq_u32 s98, s91
    s_addc_u32 s98, s98, 0
    s_cmp_ge_u32 s98, 7
    s_cselect_b32 s98, 0, s98
    s_lshl_b32 s51, s98, 13
    s_mul_i32 s70, s98, 114688
    s_add_u32 s70, s70, s88
    s_waitcnt vmcnt(6)
    s_barrier
    s_add_u32 m0, s79, 0
    s_add_u32 s83, s72, 129024
    buffer_load_dwordx4 v7, s[16:19], s83 offen lds
    s_add_u32 m0, s79, 1024
    s_add_u32 s83, s72, 129024
    buffer_load_dwordx4 v7, s[24:27], s83 offen lds
    s_bitcmp1_b32 s4, 1
    s_cselect_b32 s8, s44, s42
    s_cselect_b32 s9, s45, s43
    s_and_b32 s9, s9, 0xffff
    s_mov_b32 s10, 401408
    s_mul_i32 s29, s91, 57344
    s_and_b32 s30, s4, 1
    s_lshl_b32 s28, s85, 2
    s_add_u32 s94, s28, 2
    s_add_u32 s28, s28, s30
    s_cmp_eq_u32 s30, 0
    s_cselect_b32 s94, s94, 3
    s_lshl_b32 s28, s28, 7
    s_add_u32 s28, s28, s29
    s_lshl_b32 s94, s94, 7
    s_add_u32 s94, s94, s29
    v_lshrrev_b32 v4, 3, v0
    v_mul_u32_u24 v4, 0x380, v4
    v_and_b32 v5, 7, v0
    v_lshrrev_b32 v6, 4, v0
    v_xor_b32 v5, v5, v6
    v_lshlrev_b32 v5, 4, v5
    v_xor_b32 v6, 64, v5
    v_add_u32 v5, v4, v5
    v_add_u32 v6, v4, v6
    v_add_u32 v6, 6144, v6
    s_waitcnt vmcnt(4)
    ds_read_b64_tr_b16 v[24:25], v9 offset:16384
    ds_read_b64_tr_b16 v[28:29], v14 offset:16384
    ds_read_b64_tr_b16 v[32:33], v9 offset:17408
    ds_read_b64_tr_b16 v[36:37], v14 offset:17408
    ds_read_b64_tr_b16 v[26:27], v9 offset:24576
    ds_read_b64_tr_b16 v[30:31], v14 offset:24576
    ds_read_b64_tr_b16 v[34:35], v9 offset:25600
    ds_read_b64_tr_b16 v[38:39], v14 offset:25600
    ds_read_b128 v[88:91], v10 offset:0
    ds_read_b128 v[92:95], v10 offset:2048
    ds_read_b128 v[96:99], v10 offset:4096
    ds_read_b128 v[100:103], v10 offset:6144
    s_barrier
    s_add_u32 m0, s79, 8192
    s_add_u32 s83, s73, 0
    buffer_load_dwordx4 v7, s[16:19], s83 offen lds
    s_add_u32 m0, s79, 9216
    s_add_u32 s83, s73, 0
    buffer_load_dwordx4 v7, s[24:27], s83 offen lds
    s_waitcnt vmcnt(4) lgkmcnt(3)
    v_mfma_f32_16x16x32_bf16 v[128:131], v[24:27], v[88:91], 0
    ds_read_b128 v[104:107], v10 offset:8192
    v_mfma_f32_16x16x32_bf16 v[132:135], v[28:31], v[88:91], 0
    ds_read_b64_tr_b16 v[40:41], v9 offset:32768
    v_mfma_f32_16x16x32_bf16 v[192:195], v[32:35], v[88:91], 0
    s_add_u32 m0, s79, 16384
    s_add_u32 s83, s73, 14336
    v_mfma_f32_16x16x32_bf16 v[196:199], v[36:39], v[88:91], 0
    ds_read_b64_tr_b16 v[44:45], v14 offset:32768
    buffer_load_dwordx4 v7, s[16:19], s83 offen lds
    s_waitcnt lgkmcnt(5)
    v_mfma_f32_16x16x32_bf16 v[136:139], v[24:27], v[92:95], 0
    ds_read_b128 v[88:91], v10 offset:10240
    v_mfma_f32_16x16x32_bf16 v[140:143], v[28:31], v[92:95], 0
    ds_read_b64_tr_b16 v[48:49], v9 offset:33792
    v_mfma_f32_16x16x32_bf16 v[200:203], v[32:35], v[92:95], 0
    s_add_u32 m0, s79, 17408
    s_add_u32 s83, s73, 14336
    v_mfma_f32_16x16x32_bf16 v[204:207], v[36:39], v[92:95], 0
    ds_read_b64_tr_b16 v[52:53], v14 offset:33792
    buffer_load_dwordx4 v7, s[24:27], s83 offen lds
    s_waitcnt lgkmcnt(7)
    v_mfma_f32_16x16x32_bf16 v[144:147], v[24:27], v[96:99], 0
    ds_read_b128 v[92:95], v10 offset:12288
    v_mfma_f32_16x16x32_bf16 v[148:151], v[28:31], v[96:99], 0
    v_mfma_f32_16x16x32_bf16 v[208:211], v[32:35], v[96:99], 0
    s_add_u32 m0, s79, 24576
    s_add_u32 s83, s73, 114688
    v_mfma_f32_16x16x32_bf16 v[212:215], v[36:39], v[96:99], 0
    buffer_load_dwordx4 v7, s[16:19], s83 offen lds
    s_waitcnt lgkmcnt(7)
    v_mfma_f32_16x16x32_bf16 v[152:155], v[24:27], v[100:103], 0
    ds_read_b128 v[96:99], v10 offset:14336
    v_mfma_f32_16x16x32_bf16 v[156:159], v[28:31], v[100:103], 0
    v_mfma_f32_16x16x32_bf16 v[216:219], v[32:35], v[100:103], 0
    s_add_u32 m0, s79, 25600
    s_add_u32 s83, s73, 114688
    v_mfma_f32_16x16x32_bf16 v[220:223], v[36:39], v[100:103], 0
    buffer_load_dwordx4 v7, s[24:27], s83 offen lds
    s_waitcnt vmcnt(6) lgkmcnt(2)
    v_mfma_f32_16x16x32_bf16 v[160:163], v[24:27], v[104:107], 0
    ds_read_b128 v[100:103], v11 offset:0
    v_mfma_f32_16x16x32_bf16 v[164:167], v[28:31], v[104:107], 0
    ds_read_b64_tr_b16 v[42:43], v9 offset:0
    v_mfma_f32_16x16x32_bf16 v[224:227], v[32:35], v[104:107], 0
    v_lshrrev_b32 v115, 2, v0
    v_mfma_f32_16x16x32_bf16 v[228:231], v[36:39], v[104:107], 0
    ds_read_b64_tr_b16 v[46:47], v14 offset:0
    v_mfma_f32_16x16x32_bf16 v[168:171], v[24:27], v[88:91], 0
    ds_read_b128 v[104:107], v11 offset:2048
    v_mfma_f32_16x16x32_bf16 v[172:175], v[28:31], v[88:91], 0
    ds_read_b64_tr_b16 v[50:51], v9 offset:1024
    v_mfma_f32_16x16x32_bf16 v[232:235], v[32:35], v[88:91], 0
    s_add_u32 m0, s79, 32768
    s_add_u32 s83, s73, 129024
    v_mfma_f32_16x16x32_bf16 v[236:239], v[36:39], v[88:91], 0
    ds_read_b64_tr_b16 v[54:55], v14 offset:1024
    buffer_load_dwordx4 v7, s[16:19], s83 offen lds
    s_waitcnt lgkmcnt(7)
    v_mfma_f32_16x16x32_bf16 v[176:179], v[24:27], v[92:95], 0
    ds_read_b128 v[88:91], v11 offset:4096
    v_mfma_f32_16x16x32_bf16 v[180:183], v[28:31], v[92:95], 0
    v_bfe_u32 v114, v0, 3, 2
    v_mfma_f32_16x16x32_bf16 v[240:243], v[32:35], v[92:95], 0
    s_and_b32 s31, s4, 2
    v_mfma_f32_16x16x32_bf16 v[244:247], v[36:39], v[92:95], 0
    v_xor_b32 v114, s31, v114
    s_waitcnt lgkmcnt(7)
    v_mfma_f32_16x16x32_bf16 v[184:187], v[24:27], v[96:99], 0
    ds_read_b128 v[92:95], v11 offset:6144
    v_mfma_f32_16x16x32_bf16 v[188:191], v[28:31], v[96:99], 0
    v_lshlrev_b32 v115, 7, v115
    v_mfma_f32_16x16x32_bf16 v[248:251], v[32:35], v[96:99], 0
    s_add_u32 m0, s79, 33792
    s_add_u32 s83, s73, 129024
    v_mfma_f32_16x16x32_bf16 v[252:255], v[36:39], v[96:99], 0
    buffer_load_dwordx4 v7, s[24:27], s83 offen lds
    s_waitcnt vmcnt(6) lgkmcnt(2)
    v_mfma_f32_16x16x32_bf16 v[128:131], v[40:43], v[100:103], v[128:131]
    ds_read_b128 v[96:99], v11 offset:8192
    v_mfma_f32_16x16x32_bf16 v[132:135], v[44:47], v[100:103], v[132:135]
    ds_read_b64_tr_b16 v[56:57], v9 offset:8192
    v_mfma_f32_16x16x32_bf16 v[192:195], v[48:51], v[100:103], v[192:195]
    v_lshl_add_u32 v115, v114, 5, v115
    v_mfma_f32_16x16x32_bf16 v[196:199], v[52:55], v[100:103], v[196:199]
    ds_read_b64_tr_b16 v[60:61], v14 offset:8192
    v_mfma_f32_16x16x32_bf16 v[136:139], v[40:43], v[104:107], v[136:139]
    ds_read_b128 v[100:103], v11 offset:10240
    v_mfma_f32_16x16x32_bf16 v[140:143], v[44:47], v[104:107], v[140:143]
    ds_read_b64_tr_b16 v[64:65], v9 offset:9216
    v_mfma_f32_16x16x32_bf16 v[200:203], v[48:51], v[104:107], v[200:203]
    s_add_u32 m0, s79, 0
    s_add_u32 s83, s74, 0
    v_mfma_f32_16x16x32_bf16 v[204:207], v[52:55], v[104:107], v[204:207]
    ds_read_b64_tr_b16 v[68:69], v14 offset:9216
    buffer_load_dwordx4 v7, s[16:19], s83 offen lds
    s_waitcnt lgkmcnt(7)
    v_mfma_f32_16x16x32_bf16 v[144:147], v[40:43], v[88:91], v[144:147]
    ds_read_b128 v[104:107], v11 offset:12288
    v_mfma_f32_16x16x32_bf16 v[148:151], v[44:47], v[88:91], v[148:151]
    v_and_b32 v114, 3, v0
    v_mfma_f32_16x16x32_bf16 v[208:211], v[48:51], v[88:91], v[208:211]
    v_lshl_add_u32 v115, v114, 3, v115
    v_mfma_f32_16x16x32_bf16 v[212:215], v[52:55], v[88:91], v[212:215]
    s_lshl_b32 s30, s31, 12
    s_waitcnt lgkmcnt(7)
    v_mfma_f32_16x16x32_bf16 v[152:155], v[40:43], v[92:95], v[152:155]
    ds_read_b128 v[88:91], v11 offset:14336
    v_mfma_f32_16x16x32_bf16 v[156:159], v[44:47], v[92:95], v[156:159]
    s_lshl_b32 s31, s31, 11
    v_mfma_f32_16x16x32_bf16 v[216:219], v[48:51], v[92:95], v[216:219]
    s_add_u32 m0, s79, 1024
    s_add_u32 s83, s74, 0
    v_mfma_f32_16x16x32_bf16 v[220:223], v[52:55], v[92:95], v[220:223]
    buffer_load_dwordx4 v7, s[24:27], s83 offen lds
    s_waitcnt vmcnt(6) lgkmcnt(2)
    v_mfma_f32_16x16x32_bf16 v[160:163], v[40:43], v[96:99], v[160:163]
    ds_read_b128 v[92:95], v10 offset:16384
    v_mfma_f32_16x16x32_bf16 v[164:167], v[44:47], v[96:99], v[164:167]
    ds_read_b64_tr_b16 v[58:59], v9 offset:16384
    v_mfma_f32_16x16x32_bf16 v[224:227], v[48:51], v[96:99], v[224:227]
    s_add_u32 s31, s31, 106496
    v_mfma_f32_16x16x32_bf16 v[228:231], v[52:55], v[96:99], v[228:231]
    ds_read_b64_tr_b16 v[62:63], v14 offset:16384
    v_mfma_f32_16x16x32_bf16 v[168:171], v[40:43], v[100:103], v[168:171]
    ds_read_b128 v[96:99], v10 offset:18432
    v_mfma_f32_16x16x32_bf16 v[172:175], v[44:47], v[100:103], v[172:175]
    ds_read_b64_tr_b16 v[66:67], v9 offset:17408
    v_mfma_f32_16x16x32_bf16 v[232:235], v[48:51], v[100:103], v[232:235]
    s_add_u32 m0, s79, 8192
    s_add_u32 s83, s74, 14336
    v_mfma_f32_16x16x32_bf16 v[236:239], v[52:55], v[100:103], v[236:239]
    ds_read_b64_tr_b16 v[70:71], v14 offset:17408
    buffer_load_dwordx4 v7, s[16:19], s83 offen lds
    s_waitcnt lgkmcnt(7)
    v_mfma_f32_16x16x32_bf16 v[176:179], v[40:43], v[104:107], v[176:179]
    ds_read_b128 v[100:103], v10 offset:20480
    v_mfma_f32_16x16x32_bf16 v[180:183], v[44:47], v[104:107], v[180:183]
    v_add_u32 v108, s30, v115
    v_mfma_f32_16x16x32_bf16 v[240:243], v[48:51], v[104:107], v[240:243]
    v_add_u32 v112, s31, v115
    v_mfma_f32_16x16x32_bf16 v[244:247], v[52:55], v[104:107], v[244:247]
    v_xor_b32 v109, 32, v108
    s_waitcnt lgkmcnt(7)
    v_mfma_f32_16x16x32_bf16 v[184:187], v[40:43], v[88:91], v[184:187]
    ds_read_b128 v[104:107], v10 offset:22528
    v_mfma_f32_16x16x32_bf16 v[188:191], v[44:47], v[88:91], v[188:191]
    v_mov_b32 v126, 1
    ds_write_b32 v19, v126
    v_mfma_f32_16x16x32_bf16 v[248:251], v[48:51], v[88:91], v[248:251]
    s_add_u32 m0, s79, 9216
    s_add_u32 s83, s74, 14336
    v_mfma_f32_16x16x32_bf16 v[252:255], v[52:55], v[88:91], v[252:255]
    buffer_load_dwordx4 v7, s[24:27], s83 offen lds
    s_waitcnt vmcnt(6) lgkmcnt(3)
    v_mfma_f32_16x16x32_bf16 v[128:131], v[56:59], v[92:95], v[128:131]
    ds_read_b128 v[88:91], v10 offset:24576
    v_mfma_f32_16x16x32_bf16 v[132:135], v[60:63], v[92:95], v[132:135]
    ds_read_b64_tr_b16 v[72:73], v9 offset:24576
    v_mfma_f32_16x16x32_bf16 v[192:195], v[64:67], v[92:95], v[192:195]
    v_xor_b32 v113, 32, v112
    v_mfma_f32_16x16x32_bf16 v[196:199], v[68:71], v[92:95], v[196:199]
    ds_read_b64_tr_b16 v[76:77], v14 offset:24576
    v_mfma_f32_16x16x32_bf16 v[136:139], v[56:59], v[96:99], v[136:139]
    ds_read_b128 v[92:95], v10 offset:26624
    v_mfma_f32_16x16x32_bf16 v[140:143], v[60:63], v[96:99], v[140:143]
    ds_read_b64_tr_b16 v[80:81], v9 offset:25600
    ds_read_b32 v16, v17
    v_mfma_f32_16x16x32_bf16 v[200:203], v[64:67], v[96:99], v[200:203]
    s_add_u32 m0, s79, 16384
    s_add_u32 s83, s74, 114688
    v_mfma_f32_16x16x32_bf16 v[204:207], v[68:71], v[96:99], v[204:207]
    ds_read_b64_tr_b16 v[84:85], v14 offset:25600
    buffer_load_dwordx4 v7, s[16:19], s83 offen lds
    s_waitcnt lgkmcnt(9)
    v_mfma_f32_16x16x32_bf16 v[144:147], v[56:59], v[100:103], v[144:147]
    ds_read_b128 v[96:99], v10 offset:28672
    v_mfma_f32_16x16x32_bf16 v[148:151], v[60:63], v[100:103], v[148:151]
    v_xor_b32 v110, 64, v108
    v_mfma_f32_16x16x32_bf16 v[208:211], v[64:67], v[100:103], v[208:211]
    v_xor_b32 v114, 64, v112
    v_mfma_f32_16x16x32_bf16 v[212:215], v[68:71], v[100:103], v[212:215]
    v_xor_b32 v111, 96, v108
    s_waitcnt lgkmcnt(9)
    v_mfma_f32_16x16x32_bf16 v[152:155], v[56:59], v[104:107], v[152:155]
    ds_read_b128 v[100:103], v10 offset:30720
    v_mfma_f32_16x16x32_bf16 v[156:159], v[60:63], v[104:107], v[156:159]
    s_waitcnt lgkmcnt(3)
    v_cmp_gt_u32 vcc, 1, v16
    v_mfma_f32_16x16x32_bf16 v[216:219], v[64:67], v[104:107], v[216:219]
    s_add_u32 m0, s79, 17408
    s_add_u32 s83, s74, 114688
    v_mfma_f32_16x16x32_bf16 v[220:223], v[68:71], v[104:107], v[220:223]
    buffer_load_dwordx4 v7, s[24:27], s83 offen lds
    s_waitcnt vmcnt(4) lgkmcnt(2)
    v_mfma_f32_16x16x32_bf16 v[160:163], v[56:59], v[88:91], v[160:163]
    ds_read_b128 v[104:107], v11 offset:16384
    s_cbranch_vccnz PG_1
PG_1_r:
    v_mfma_f32_16x16x32_bf16 v[164:167], v[60:63], v[88:91], v[164:167]
    ds_read_b64_tr_b16 v[74:75], v9 offset:32768
    v_mfma_f32_16x16x32_bf16 v[224:227], v[64:67], v[88:91], v[224:227]
    ds_read_b64_tr_b16 v[78:79], v14 offset:32768
    v_mfma_f32_16x16x32_bf16 v[228:231], v[68:71], v[88:91], v[228:231]
    s_add_u32 m0, s89, 0
    s_add_u32 s83, s74, 129024
    v_mfma_f32_16x16x32_bf16 v[168:171], v[56:59], v[92:95], v[168:171]
    ds_read_b128 v[88:91], v11 offset:18432
    ds_read_b64_tr_b16 v[82:83], v9 offset:33792
    v_mfma_f32_16x16x32_bf16 v[172:175], v[60:63], v[92:95], v[172:175]
    buffer_load_dwordx4 v7, s[16:19], s83 offen lds
    ds_read_b64_tr_b16 v[86:87], v14 offset:33792
    v_mfma_f32_16x16x32_bf16 v[232:235], v[64:67], v[92:95], v[232:235]
    ds_read_b64_tr_b16 v[24:25], v9 offset:0
    v_mfma_f32_16x16x32_bf16 v[236:239], v[68:71], v[92:95], v[236:239]
    s_add_u32 m0, s89, 1024
    s_add_u32 s83, s74, 129024
    s_waitcnt lgkmcnt(8)
    v_mfma_f32_16x16x32_bf16 v[176:179], v[56:59], v[96:99], v[176:179]
    ds_read_b128 v[92:95], v11 offset:20480
    ds_read_b64_tr_b16 v[28:29], v14 offset:0
    v_mfma_f32_16x16x32_bf16 v[180:183], v[60:63], v[96:99], v[180:183]
    buffer_load_dwordx4 v7, s[24:27], s83 offen lds
    ds_read_b64_tr_b16 v[32:33], v9 offset:1024
    v_mfma_f32_16x16x32_bf16 v[240:243], v[64:67], v[96:99], v[240:243]
    ds_read_b64_tr_b16 v[36:37], v14 offset:1024
    v_mfma_f32_16x16x32_bf16 v[244:247], v[68:71], v[96:99], v[244:247]
    s_add_u32 m0, s89, 2048
    s_add_u32 s83, s75, 0
    s_waitcnt lgkmcnt(11)
    v_mfma_f32_16x16x32_bf16 v[184:187], v[56:59], v[100:103], v[184:187]
    ds_read_b128 v[96:99], v11 offset:22528
    buffer_load_dwordx4 v7, s[16:19], s83 offen lds
    v_mfma_f32_16x16x32_bf16 v[188:191], v[60:63], v[100:103], v[188:191]
    v_xor_b32 v115, 96, v112
    v_mfma_f32_16x16x32_bf16 v[248:251], v[64:67], v[100:103], v[248:251]
    s_add_u32 m0, s89, 3072
    s_add_u32 s83, s75, 0
    v_mfma_f32_16x16x32_bf16 v[252:255], v[68:71], v[100:103], v[252:255]
    buffer_load_dwordx4 v7, s[24:27], s83 offen lds
    s_waitcnt vmcnt(6) lgkmcnt(1)
    v_mfma_f32_16x16x32_bf16 v[128:131], v[72:75], v[104:107], v[128:131]
    ds_read_b128 v[100:103], v11 offset:24576
    v_mfma_f32_16x16x32_bf16 v[132:135], v[76:79], v[104:107], v[132:135]
    ds_read_b64_tr_b16 v[26:27], v9 offset:8192
    v_mfma_f32_16x16x32_bf16 v[192:195], v[80:83], v[104:107], v[192:195]
    s_add_u32 m0, s79, 24576
    s_add_u32 s83, s75, 14336
    v_mfma_f32_16x16x32_bf16 v[196:199], v[84:87], v[104:107], v[196:199]
    ds_read_b64_tr_b16 v[30:31], v14 offset:8192
    buffer_load_dwordx4 v7, s[16:19], s83 offen lds
    v_mfma_f32_16x16x32_bf16 v[136:139], v[72:75], v[88:91], v[136:139]
    ds_read_b128 v[104:107], v11 offset:26624
    v_mfma_f32_16x16x32_bf16 v[140:143], v[76:79], v[88:91], v[140:143]
    ds_read_b64_tr_b16 v[34:35], v9 offset:9216
    v_mfma_f32_16x16x32_bf16 v[200:203], v[80:83], v[88:91], v[200:203]
    s_add_u32 m0, s79, 25600
    s_add_u32 s83, s75, 14336
    v_mfma_f32_16x16x32_bf16 v[204:207], v[84:87], v[88:91], v[204:207]
    ds_read_b64_tr_b16 v[38:39], v14 offset:9216
    buffer_load_dwordx4 v7, s[24:27], s83 offen lds
    v_mfma_f32_16x16x32_bf16 v[144:147], v[72:75], v[92:95], v[144:147]
    ds_read_b128 v[88:91], v11 offset:28672
    v_mfma_f32_16x16x32_bf16 v[148:151], v[76:79], v[92:95], v[148:151]
    s_lshl_b32 s93, s5, 1
    v_mfma_f32_16x16x32_bf16 v[208:211], v[80:83], v[92:95], v[208:211]
    s_add_u32 m0, s79, 32768
    s_add_u32 s83, s75, 114688
    v_mfma_f32_16x16x32_bf16 v[212:215], v[84:87], v[92:95], v[212:215]
    buffer_load_dwordx4 v7, s[16:19], s83 offen lds
    s_waitcnt lgkmcnt(7)
    v_mfma_f32_16x16x32_bf16 v[152:155], v[72:75], v[96:99], v[152:155]
    ds_read_b128 v[92:95], v11 offset:30720
    v_mfma_f32_16x16x32_bf16 v[156:159], v[76:79], v[96:99], v[156:159]
    s_add_u32 s93, s93, s85
    v_mfma_f32_16x16x32_bf16 v[216:219], v[80:83], v[96:99], v[216:219]
    s_add_u32 m0, s79, 33792
    s_add_u32 s83, s75, 114688
    v_mfma_f32_16x16x32_bf16 v[220:223], v[84:87], v[96:99], v[220:223]
    buffer_load_dwordx4 v7, s[24:27], s83 offen lds
    s_waitcnt vmcnt(6) lgkmcnt(2)
    v_mfma_f32_16x16x32_bf16 v[160:163], v[72:75], v[100:103], v[160:163]
    ds_read_b128 v[96:99], v10 offset:32768
    v_mfma_f32_16x16x32_bf16 v[164:167], v[76:79], v[100:103], v[164:167]
    ds_read_b64_tr_b16 v[40:41], v9 offset:16384
    v_mfma_f32_16x16x32_bf16 v[224:227], v[80:83], v[100:103], v[224:227]
    ds_read_b64_tr_b16 v[44:45], v14 offset:16384
    v_mfma_f32_16x16x32_bf16 v[228:231], v[84:87], v[100:103], v[228:231]
    s_add_u32 m0, s79, 0
    s_add_u32 s83, s75, 129024
    v_mfma_f32_16x16x32_bf16 v[168:171], v[72:75], v[104:107], v[168:171]
    ds_read_b128 v[100:103], v11 offset:32768
    ds_read_b64_tr_b16 v[48:49], v9 offset:17408
    v_mfma_f32_16x16x32_bf16 v[172:175], v[76:79], v[104:107], v[172:175]
    buffer_load_dwordx4 v7, s[16:19], s83 offen lds
    ds_read_b64_tr_b16 v[52:53], v14 offset:17408
    v_mfma_f32_16x16x32_bf16 v[232:235], v[80:83], v[104:107], v[232:235]
    ds_read_b64_tr_b16 v[42:43], v125 offset:0
    v_mfma_f32_16x16x32_bf16 v[236:239], v[84:87], v[104:107], v[236:239]
    s_add_u32 m0, s79, 1024
    s_add_u32 s83, s75, 129024
    s_waitcnt lgkmcnt(8)
    v_mfma_f32_16x16x32_bf16 v[176:179], v[72:75], v[88:91], v[176:179]
    ds_read_b128 v[104:107], v10 offset:34816
    ds_read_b64_tr_b16 v[46:47], v15 offset:0
    v_mfma_f32_16x16x32_bf16 v[180:183], v[76:79], v[88:91], v[180:183]
    buffer_load_dwordx4 v7, s[24:27], s83 offen lds
    ds_read_b64_tr_b16 v[50:51], v125 offset:1024
    v_mfma_f32_16x16x32_bf16 v[240:243], v[80:83], v[88:91], v[240:243]
    ds_read_b64_tr_b16 v[54:55], v15 offset:1024
    v_mfma_f32_16x16x32_bf16 v[244:247], v[84:87], v[88:91], v[244:247]
    s_add_u32 m0, s79, 8192
    s_add_u32 s83, s76, 0
    s_waitcnt lgkmcnt(11)
    v_mfma_f32_16x16x32_bf16 v[184:187], v[72:75], v[92:95], v[184:187]
    ds_read_b128 v[88:91], v11 offset:34816
    buffer_load_dwordx4 v7, s[16:19], s83 offen lds
    v_mfma_f32_16x16x32_bf16 v[188:191], v[76:79], v[92:95], v[188:191]
    v_mov_b32 v126, 2
    ds_write_b32 v19, v126
    v_mfma_f32_16x16x32_bf16 v[248:251], v[80:83], v[92:95], v[248:251]
    s_add_u32 m0, s79, 9216
    s_add_u32 s83, s76, 0
    v_mfma_f32_16x16x32_bf16 v[252:255], v[84:87], v[92:95], v[252:255]
    buffer_load_dwordx4 v7, s[24:27], s83 offen lds
    s_waitcnt vmcnt(8) lgkmcnt(2)
    v_mfma_f32_16x16x32_bf16 v[128:131], v[24:27], v[96:99], v[128:131]
    ds_read_b128 v[92:95], v10 offset:36864
    v_mfma_f32_16x16x32_bf16 v[128:131], v[40:43], v[100:103], v[128:131]
    ds_read_b64_tr_b16 v[56:57], v125 offset:2048
    v_mfma_f32_16x16x32_bf16 v[132:135], v[28:31], v[96:99], v[132:135]
    s_add_u32 m0, s79, 16384
    s_add_u32 s83, s76, 14336
    v_mfma_f32_16x16x32_bf16 v[132:135], v[44:47], v[100:103], v[132:135]
    ds_read_b64_tr_b16 v[60:61], v15 offset:2048
    buffer_load_dwordx4 v7, s[16:19], s83 offen lds
    v_mfma_f32_16x16x32_bf16 v[192:195], v[32:35], v[96:99], v[192:195]
    s_lshl_b32 s93, s93, 10
    v_mfma_f32_16x16x32_bf16 v[192:195], v[48:51], v[100:103], v[192:195]
    ds_read_b64_tr_b16 v[64:65], v125 offset:3072
    ds_read_b32 v16, v17
    v_mfma_f32_16x16x32_bf16 v[196:199], v[36:39], v[96:99], v[196:199]
    s_add_u32 m0, s79, 17408
    s_add_u32 s83, s76, 14336
    v_mfma_f32_16x16x32_bf16 v[196:199], v[52:55], v[100:103], v[196:199]
    ds_read_b64_tr_b16 v[68:69], v15 offset:3072
    buffer_load_dwordx4 v7, s[24:27], s83 offen lds
    v_mfma_f32_16x16x32_bf16 v[136:139], v[24:27], v[104:107], v[136:139]
    ds_read_b128 v[96:99], v11 offset:36864
    s_waitcnt lgkmcnt(8)
    v_mfma_f32_16x16x32_bf16 v[136:139], v[40:43], v[88:91], v[136:139]
    ds_read_b128 v[100:103], v10 offset:38912
    v_mfma_f32_16x16x32_bf16 v[140:143], v[28:31], v[104:107], v[140:143]
    s_add_u32 m0, s89, 0
    s_add_u32 s83, s76, 114688
    v_mfma_f32_16x16x32_bf16 v[140:143], v[44:47], v[88:91], v[140:143]
    buffer_load_dwordx4 v7, s[16:19], s83 offen lds
    v_mfma_f32_16x16x32_bf16 v[200:203], v[32:35], v[104:107], v[200:203]
    s_add_u32 s93, s93, 18526208
    v_mfma_f32_16x16x32_bf16 v[200:203], v[48:51], v[88:91], v[200:203]
    s_waitcnt lgkmcnt(3)
    v_cmp_gt_u32 vcc, 2, v16
    v_mfma_f32_16x16x32_bf16 v[204:207], v[36:39], v[104:107], v[204:207]
    s_add_u32 m0, s89, 1024
    s_add_u32 s83, s76, 114688
    v_mfma_f32_16x16x32_bf16 v[204:207], v[52:55], v[88:91], v[204:207]
    buffer_load_dwordx4 v7, s[24:27], s83 offen lds
    s_waitcnt vmcnt(10) lgkmcnt(2)
    v_mfma_f32_16x16x32_bf16 v[144:147], v[24:27], v[92:95], v[144:147]
    ds_read_b128 v[104:107], v11 offset:38912
    s_cbranch_vccnz PG_2
PG_2_r:
    s_waitcnt lgkmcnt(2)
    v_mfma_f32_16x16x32_bf16 v[144:147], v[40:43], v[96:99], v[144:147]
    ds_read_b128 v[88:91], v10 offset:40960
    ds_read_b64_tr_b16 v[58:59], v9 offset:24576
    v_mfma_f32_16x16x32_bf16 v[148:151], v[28:31], v[92:95], v[148:151]
    s_add_u32 m0, s89, 16384
    s_add_u32 s83, s76, 129024
    v_mfma_f32_16x16x32_bf16 v[148:151], v[44:47], v[96:99], v[148:151]
    ds_read_b64_tr_b16 v[62:63], v14 offset:24576
    buffer_load_dwordx4 v7, s[16:19], s83 offen lds
    v_mfma_f32_16x16x32_bf16 v[208:211], v[32:35], v[92:95], v[208:211]
    s_and_b32 s31, s4, 1
    v_mfma_f32_16x16x32_bf16 v[208:211], v[48:51], v[96:99], v[208:211]
    ds_read_b64_tr_b16 v[66:67], v9 offset:25600
    v_mfma_f32_16x16x32_bf16 v[212:215], v[36:39], v[92:95], v[212:215]
    s_add_u32 m0, s89, 17408
    s_add_u32 s83, s76, 129024
    v_mfma_f32_16x16x32_bf16 v[212:215], v[52:55], v[96:99], v[212:215]
    ds_read_b64_tr_b16 v[70:71], v14 offset:25600
    buffer_load_dwordx4 v7, s[24:27], s83 offen lds
    s_waitcnt lgkmcnt(6)
    v_mfma_f32_16x16x32_bf16 v[152:155], v[24:27], v[100:103], v[152:155]
    ds_read_b128 v[92:95], v11 offset:40960
    s_waitcnt lgkmcnt(6)
    v_mfma_f32_16x16x32_bf16 v[152:155], v[40:43], v[104:107], v[152:155]
    ds_read_b128 v[96:99], v10 offset:43008
    v_mfma_f32_16x16x32_bf16 v[156:159], v[28:31], v[100:103], v[156:159]
    s_add_u32 m0, s89, 18432
    s_add_u32 s83, s77, 0
    v_mfma_f32_16x16x32_bf16 v[156:159], v[44:47], v[104:107], v[156:159]
    buffer_load_dwordx4 v7, s[16:19], s83 offen lds
    v_mfma_f32_16x16x32_bf16 v[216:219], v[32:35], v[100:103], v[216:219]
    s_mul_i32 s31, s31, 114688
    v_mfma_f32_16x16x32_bf16 v[216:219], v[48:51], v[104:107], v[216:219]
    s_sub_u32 s92, s92, s31
    v_mfma_f32_16x16x32_bf16 v[220:223], v[36:39], v[100:103], v[220:223]
    s_add_u32 m0, s89, 19456
    s_add_u32 s83, s77, 0
    v_mfma_f32_16x16x32_bf16 v[220:223], v[52:55], v[104:107], v[220:223]
    buffer_load_dwordx4 v7, s[24:27], s83 offen lds
    s_waitcnt vmcnt(12) lgkmcnt(2)
    v_mfma_f32_16x16x32_bf16 v[160:163], v[24:27], v[88:91], v[160:163]
    ds_read_b128 v[100:103], v11 offset:43008
    s_waitcnt lgkmcnt(2)
    v_mfma_f32_16x16x32_bf16 v[160:163], v[40:43], v[92:95], v[160:163]
    ds_read_b128 v[104:107], v10 offset:45056
    ds_read_b64_tr_b16 v[72:73], v9 offset:32768
    v_mfma_f32_16x16x32_bf16 v[164:167], v[28:31], v[88:91], v[164:167]
    s_add_u32 m0, s89, 2048
    s_add_u32 s83, s77, 14336
    v_mfma_f32_16x16x32_bf16 v[164:167], v[44:47], v[92:95], v[164:167]
    ds_read_b64_tr_b16 v[76:77], v14 offset:32768
    buffer_load_dwordx4 v7, s[16:19], s83 offen lds
    v_mfma_f32_16x16x32_bf16 v[224:227], v[32:35], v[88:91], v[224:227]
    s_mul_i32 s31, s85, 57344
    v_mfma_f32_16x16x32_bf16 v[224:227], v[48:51], v[92:95], v[224:227]
    ds_read_b64_tr_b16 v[80:81], v9 offset:33792
    v_mfma_f32_16x16x32_bf16 v[228:231], v[36:39], v[88:91], v[228:231]
    s_add_u32 m0, s89, 3072
    s_add_u32 s83, s77, 14336
    v_mfma_f32_16x16x32_bf16 v[228:231], v[52:55], v[92:95], v[228:231]
    ds_read_b64_tr_b16 v[84:85], v14 offset:33792
    buffer_load_dwordx4 v7, s[24:27], s83 offen lds
    s_waitcnt lgkmcnt(6)
    v_mfma_f32_16x16x32_bf16 v[168:171], v[24:27], v[96:99], v[168:171]
    ds_read_b128 v[88:91], v11 offset:45056
    s_waitcnt lgkmcnt(6)
    v_mfma_f32_16x16x32_bf16 v[168:171], v[40:43], v[100:103], v[168:171]
    ds_read_b128 v[92:95], v10 offset:47104
    v_mfma_f32_16x16x32_bf16 v[172:175], v[28:31], v[96:99], v[172:175]
    s_add_u32 m0, s79, 24576
    s_add_u32 s83, s77, 114688
    v_mfma_f32_16x16x32_bf16 v[172:175], v[44:47], v[100:103], v[172:175]
    buffer_load_dwordx4 v7, s[16:19], s83 offen lds
    v_mfma_f32_16x16x32_bf16 v[232:235], v[32:35], v[96:99], v[232:235]
    s_add_u32 s92, s92, s31
    v_mfma_f32_16x16x32_bf16 v[232:235], v[48:51], v[100:103], v[232:235]
    s_add_u32 s46, s46, s92
    v_mfma_f32_16x16x32_bf16 v[236:239], v[36:39], v[96:99], v[236:239]
    s_add_u32 m0, s79, 25600
    s_add_u32 s83, s77, 114688
    v_mfma_f32_16x16x32_bf16 v[236:239], v[52:55], v[100:103], v[236:239]
    buffer_load_dwordx4 v7, s[24:27], s83 offen lds
    s_waitcnt vmcnt(14) lgkmcnt(2)
    v_mfma_f32_16x16x32_bf16 v[176:179], v[24:27], v[104:107], v[176:179]
    ds_read_b128 v[96:99], v11 offset:47104
    s_waitcnt lgkmcnt(2)
    v_mfma_f32_16x16x32_bf16 v[176:179], v[40:43], v[88:91], v[176:179]
    ds_read_b128 v[100:103], v10 offset:49152
    ds_read_b64_tr_b16 v[74:75], v9 offset:0
    v_mfma_f32_16x16x32_bf16 v[180:183], v[28:31], v[104:107], v[180:183]
    s_add_u32 s47, s47, s92
    v_mfma_f32_16x16x32_bf16 v[180:183], v[44:47], v[88:91], v[180:183]
    ds_read_b64_tr_b16 v[78:79], v14 offset:0
    v_mfma_f32_16x16x32_bf16 v[240:243], v[32:35], v[104:107], v[240:243]
    s_add_u32 s48, s48, s92
    v_mfma_f32_16x16x32_bf16 v[240:243], v[48:51], v[88:91], v[240:243]
    ds_read_b64_tr_b16 v[82:83], v9 offset:1024
    v_mfma_f32_16x16x32_bf16 v[244:247], v[36:39], v[104:107], v[244:247]
    s_add_u32 m0, s79, 32768
    s_add_u32 s83, s77, 129024
    v_mfma_f32_16x16x32_bf16 v[244:247], v[52:55], v[88:91], v[244:247]
    ds_read_b64_tr_b16 v[86:87], v14 offset:1024
    buffer_load_dwordx4 v7, s[16:19], s83 offen lds
    s_waitcnt lgkmcnt(6)
    v_mfma_f32_16x16x32_bf16 v[184:187], v[24:27], v[92:95], v[184:187]
    ds_read_b128 v[104:107], v11 offset:49152
    s_waitcnt lgkmcnt(6)
    v_mfma_f32_16x16x32_bf16 v[184:187], v[40:43], v[96:99], v[184:187]
    ds_read_b128 v[88:91], v10 offset:51200
    v_mfma_f32_16x16x32_bf16 v[188:191], v[28:31], v[92:95], v[188:191]
    s_add_u32 s49, s49, s92
    v_mfma_f32_16x16x32_bf16 v[188:191], v[44:47], v[96:99], v[188:191]
    s_add_u32 s50, s50, s92
    v_mfma_f32_16x16x32_bf16 v[248:251], v[32:35], v[92:95], v[248:251]
    s_add_u32 s51, s51, s92
    v_mfma_f32_16x16x32_bf16 v[248:251], v[48:51], v[96:99], v[248:251]
    v_mov_b32 v126, 3
    ds_write_b32 v19, v126
    v_mfma_f32_16x16x32_bf16 v[252:255], v[36:39], v[92:95], v[252:255]
    s_add_u32 m0, s79, 33792
    s_add_u32 s83, s77, 129024
    v_mfma_f32_16x16x32_bf16 v[252:255], v[52:55], v[96:99], v[252:255]
    buffer_load_dwordx4 v7, s[24:27], s83 offen lds
    s_waitcnt vmcnt(14) lgkmcnt(3)
    v_mfma_f32_16x16x32_bf16 v[128:131], v[56:59], v[100:103], v[128:131]
    ds_read_b128 v[92:95], v11 offset:51200
    s_waitcnt lgkmcnt(3)
    v_mfma_f32_16x16x32_bf16 v[128:131], v[72:75], v[104:107], v[128:131]
    ds_read_b128 v[96:99], v10 offset:53248
    ds_read_b64_tr_b16 v[24:25], v9 offset:8192
    v_mfma_f32_16x16x32_bf16 v[132:135], v[60:63], v[100:103], v[132:135]
    s_lshl_b32 s29, s85, 6
    v_mfma_f32_16x16x32_bf16 v[132:135], v[76:79], v[104:107], v[132:135]
    ds_read_b64_tr_b16 v[28:29], v14 offset:8192
    v_mfma_f32_16x16x32_bf16 v[192:195], v[64:67], v[100:103], v[192:195]
    s_and_b32 s31, s4, 1
    v_mfma_f32_16x16x32_bf16 v[192:195], v[80:83], v[104:107], v[192:195]
    ds_read_b64_tr_b16 v[32:33], v9 offset:9216
    ds_read_b32 v16, v17
    v_mfma_f32_16x16x32_bf16 v[196:199], v[68:71], v[100:103], v[196:199]
    s_add_u32 m0, s79, 0
    s_add_u32 s83, s78, 0
    v_mfma_f32_16x16x32_bf16 v[196:199], v[84:87], v[104:107], v[196:199]
    ds_read_b64_tr_b16 v[36:37], v14 offset:9216
    buffer_load_dwordx4 v7, s[16:19], s83 offen lds
    s_waitcnt lgkmcnt(8)
    v_mfma_f32_16x16x32_bf16 v[136:139], v[56:59], v[88:91], v[136:139]
    ds_read_b128 v[100:103], v11 offset:53248
    s_waitcnt lgkmcnt(7)
    v_mfma_f32_16x16x32_bf16 v[136:139], v[72:75], v[92:95], v[136:139]
    ds_read_b128 v[104:107], v10 offset:55296
    v_mfma_f32_16x16x32_bf16 v[140:143], v[60:63], v[88:91], v[140:143]
    s_lshl_b32 s31, s31, 5
    v_mfma_f32_16x16x32_bf16 v[140:143], v[76:79], v[92:95], v[140:143]
    s_add_u32 s29, s29, s31
    v_mfma_f32_16x16x32_bf16 v[200:203], v[64:67], v[88:91], v[200:203]
    s_lshl_b32 s30, s5, 7
    v_mfma_f32_16x16x32_bf16 v[200:203], v[80:83], v[92:95], v[200:203]
    s_waitcnt lgkmcnt(3)
    v_cmp_gt_u32 vcc, 3, v16
    v_mfma_f32_16x16x32_bf16 v[204:207], v[68:71], v[88:91], v[204:207]
    s_add_u32 m0, s79, 1024
    s_add_u32 s83, s78, 0
    v_mfma_f32_16x16x32_bf16 v[204:207], v[84:87], v[92:95], v[204:207]
    buffer_load_dwordx4 v7, s[24:27], s83 offen lds
    s_waitcnt vmcnt(14) lgkmcnt(2)
    v_mfma_f32_16x16x32_bf16 v[144:147], v[56:59], v[96:99], v[144:147]
    ds_read_b128 v[88:91], v11 offset:55296
    s_cbranch_vccnz PG_3
PG_3_r:
    s_waitcnt lgkmcnt(2)
    v_mfma_f32_16x16x32_bf16 v[144:147], v[72:75], v[100:103], v[144:147]
    ds_read_b128 v[92:95], v10 offset:57344
    ds_read_b64_tr_b16 v[26:27], v9 offset:16384
    v_mfma_f32_16x16x32_bf16 v[148:151], v[60:63], v[96:99], v[148:151]
    s_add_u32 s30, s30, s29
    v_mfma_f32_16x16x32_bf16 v[148:151], v[76:79], v[100:103], v[148:151]
    ds_read_b64_tr_b16 v[30:31], v14 offset:16384
    v_mfma_f32_16x16x32_bf16 v[208:211], v[64:67], v[96:99], v[208:211]
    v_lshlrev_b32 v117, 4, v22
    v_mfma_f32_16x16x32_bf16 v[208:211], v[80:83], v[100:103], v[208:211]
    ds_read_b64_tr_b16 v[34:35], v9 offset:17408
    v_mfma_f32_16x16x32_bf16 v[212:215], v[68:71], v[96:99], v[212:215]
    s_add_u32 m0, s79, 8192
    s_add_u32 s83, s78, 14336
    v_mfma_f32_16x16x32_bf16 v[212:215], v[84:87], v[100:103], v[212:215]
    ds_read_b64_tr_b16 v[38:39], v14 offset:17408
    buffer_load_dwordx4 v7, s[16:19], s83 offen lds
    s_waitcnt lgkmcnt(6)
    v_mfma_f32_16x16x32_bf16 v[152:155], v[56:59], v[104:107], v[152:155]
    ds_read_b128 v[96:99], v11 offset:57344
    s_waitcnt lgkmcnt(6)
    v_mfma_f32_16x16x32_bf16 v[152:155], v[72:75], v[88:91], v[152:155]
    ds_read_b128 v[100:103], v10 offset:59392
    v_mfma_f32_16x16x32_bf16 v[156:159], v[60:63], v[104:107], v[156:159]
    s_add_u32 m0, s79, 9216
    s_add_u32 s83, s78, 14336
    v_mfma_f32_16x16x32_bf16 v[156:159], v[76:79], v[88:91], v[156:159]
    buffer_load_dwordx4 v7, s[24:27], s83 offen lds
    v_mfma_f32_16x16x32_bf16 v[216:219], v[64:67], v[104:107], v[216:219]
    v_lshl_add_u32 v117, v21, 2, v117
    v_mfma_f32_16x16x32_bf16 v[216:219], v[80:83], v[88:91], v[216:219]
    v_add_u32 v116, s30, v117
    v_mfma_f32_16x16x32_bf16 v[220:223], v[68:71], v[104:107], v[220:223]
    s_add_u32 m0, s89, 32768
    s_add_u32 s83, s28, 0
    v_mfma_f32_16x16x32_bf16 v[220:223], v[84:87], v[88:91], v[220:223]
    buffer_load_dwordx4 v5, s[8:11], s83 offen lds
    s_waitcnt vmcnt(15) lgkmcnt(2)
    v_mfma_f32_16x16x32_bf16 v[160:163], v[56:59], v[92:95], v[160:163]
    ds_read_b128 v[104:107], v11 offset:59392
    s_waitcnt lgkmcnt(2)
    v_mfma_f32_16x16x32_bf16 v[160:163], v[72:75], v[96:99], v[160:163]
    ds_read_b128 v[88:91], v10 offset:61440
    ds_read_b64_tr_b16 v[40:41], v125 offset:0
    v_mfma_f32_16x16x32_bf16 v[164:167], v[60:63], v[92:95], v[164:167]
    s_lshl_b32 s29, s29, 2
    v_mfma_f32_16x16x32_bf16 v[164:167], v[76:79], v[96:99], v[164:167]
    ds_read_b64_tr_b16 v[44:45], v15 offset:0
    v_mfma_f32_16x16x32_bf16 v[224:227], v[64:67], v[92:95], v[224:227]
    s_add_u32 s29, s29, 155648
    v_mfma_f32_16x16x32_bf16 v[224:227], v[80:83], v[96:99], v[224:227]
    ds_read_b64_tr_b16 v[48:49], v125 offset:1024
    v_mfma_f32_16x16x32_bf16 v[228:231], v[68:71], v[92:95], v[228:231]
    s_add_u32 m0, s79, 16384
    s_add_u32 s83, s78, 114688
    v_mfma_f32_16x16x32_bf16 v[228:231], v[84:87], v[96:99], v[228:231]
    ds_read_b64_tr_b16 v[52:53], v15 offset:1024
    buffer_load_dwordx4 v7, s[16:19], s83 offen lds
    s_waitcnt lgkmcnt(6)
    v_mfma_f32_16x16x32_bf16 v[168:171], v[56:59], v[100:103], v[168:171]
    ds_read_b128 v[92:95], v11 offset:61440
    s_waitcnt lgkmcnt(6)
    v_mfma_f32_16x16x32_bf16 v[168:171], v[72:75], v[104:107], v[168:171]
    ds_read_b128 v[96:99], v10 offset:63488
    v_mfma_f32_16x16x32_bf16 v[172:175], v[60:63], v[100:103], v[172:175]
    s_add_u32 m0, s79, 17408
    s_add_u32 s83, s78, 114688
    v_mfma_f32_16x16x32_bf16 v[172:175], v[76:79], v[104:107], v[172:175]
    buffer_load_dwordx4 v7, s[24:27], s83 offen lds
    v_mfma_f32_16x16x32_bf16 v[232:235], v[64:67], v[100:103], v[232:235]
    v_lshl_add_u32 v117, v117, 2, s29
    v_mfma_f32_16x16x32_bf16 v[232:235], v[80:83], v[104:107], v[232:235]
    s_lshl_b32 s29, s91, 8
    v_mfma_f32_16x16x32_bf16 v[236:239], v[68:71], v[100:103], v[236:239]
    s_add_u32 m0, s89, 32768
    s_add_u32 s83, s28, 0
    v_mfma_f32_16x16x32_bf16 v[236:239], v[84:87], v[104:107], v[236:239]
    buffer_load_dwordx4 v6, s[8:11], s83 offen offset:1024 lds
    s_waitcnt vmcnt(16) lgkmcnt(2)
    v_mfma_f32_16x16x32_bf16 v[176:179], v[56:59], v[88:91], v[176:179]
    ds_read_b128 v[100:103], v11 offset:63488
    s_waitcnt lgkmcnt(2)
    v_mfma_f32_16x16x32_bf16 v[176:179], v[72:75], v[92:95], v[176:179]
    ds_read_b128 v[104:107], v12 offset:0
    ds_read_b64_tr_b16 v[42:43], v125 offset:16384
    v_mfma_f32_16x16x32_bf16 v[180:183], v[60:63], v[88:91], v[180:183]
    s_lshr_b32 s31, s4, 1
    v_mfma_f32_16x16x32_bf16 v[180:183], v[76:79], v[92:95], v[180:183]
    ds_read_b64_tr_b16 v[46:47], v15 offset:16384
    v_mfma_f32_16x16x32_bf16 v[240:243], v[64:67], v[88:91], v[240:243]
    s_lshl_b32 s31, s31, 7
    v_mfma_f32_16x16x32_bf16 v[240:243], v[80:83], v[92:95], v[240:243]
    ds_read_b64_tr_b16 v[50:51], v125 offset:17408
    v_mfma_f32_16x16x32_bf16 v[244:247], v[68:71], v[88:91], v[244:247]
    s_add_u32 m0, s89, 0
    s_add_u32 s83, s78, 129024
    v_mfma_f32_16x16x32_bf16 v[244:247], v[84:87], v[92:95], v[244:247]
    ds_read_b64_tr_b16 v[54:55], v15 offset:17408
    buffer_load_dwordx4 v7, s[16:19], s83 offen lds
    s_waitcnt lgkmcnt(6)
    v_mfma_f32_16x16x32_bf16 v[184:187], v[56:59], v[96:99], v[184:187]
    ds_read_b128 v[88:91], v13 offset:0
    s_waitcnt lgkmcnt(6)
    v_mfma_f32_16x16x32_bf16 v[184:187], v[72:75], v[100:103], v[184:187]
    ds_read_b128 v[92:95], v12 offset:2048
    v_mfma_f32_16x16x32_bf16 v[188:191], v[60:63], v[96:99], v[188:191]
    s_add_u32 m0, s89, 1024
    s_add_u32 s83, s78, 129024
    v_mfma_f32_16x16x32_bf16 v[188:191], v[76:79], v[100:103], v[188:191]
    buffer_load_dwordx4 v7, s[24:27], s83 offen lds
    v_mfma_f32_16x16x32_bf16 v[248:251], v[64:67], v[96:99], v[248:251]
    s_add_u32 s29, s29, s31
    v_mfma_f32_16x16x32_bf16 v[248:251], v[80:83], v[100:103], v[248:251]
    v_mov_b32 v126, 4
    ds_write_b32 v19, v126
    v_mfma_f32_16x16x32_bf16 v[252:255], v[68:71], v[96:99], v[252:255]
    s_add_u32 m0, s89, 34816
    s_add_u32 s83, s28, 14336
    v_mfma_f32_16x16x32_bf16 v[252:255], v[84:87], v[100:103], v[252:255]
    buffer_load_dwordx4 v5, s[8:11], s83 offen lds
    s_waitcnt vmcnt(17) lgkmcnt(3)
    v_mfma_f32_16x16x32_bf16 v[128:131], v[24:27], v[104:107], v[128:131]
    ds_read_b128 v[96:99], v13 offset:2048
    s_waitcnt lgkmcnt(3)
    v_mfma_f32_16x16x32_bf16 v[128:131], v[40:43], v[88:91], v[128:131]
    ds_read_b128 v[100:103], v12 offset:4096
    ds_read_b64_tr_b16 v[56:57], v125 offset:18432
    v_mfma_f32_16x16x32_bf16 v[132:135], v[28:31], v[104:107], v[132:135]
    v_mul_u32_u24 v116, 0x700, v116
    v_mfma_f32_16x16x32_bf16 v[132:135], v[44:47], v[88:91], v[132:135]
    ds_read_b64_tr_b16 v[60:61], v15 offset:18432
    v_mfma_f32_16x16x32_bf16 v[192:195], v[32:35], v[104:107], v[192:195]
    v_lshl_add_u32 v116, v20, 2, v116
    v_mfma_f32_16x16x32_bf16 v[192:195], v[48:51], v[88:91], v[192:195]
    ds_read_b64_tr_b16 v[64:65], v125 offset:19456
    ds_read_b32 v16, v17
    v_mfma_f32_16x16x32_bf16 v[196:199], v[36:39], v[104:107], v[196:199]
    s_add_u32 m0, s89, 16384
    s_add_u32 s83, s64, 0
    v_mfma_f32_16x16x32_bf16 v[196:199], v[52:55], v[88:91], v[196:199]
    ds_read_b64_tr_b16 v[68:69], v15 offset:19456
    buffer_load_dwordx4 v2, s[12:15], s83 offen lds
    s_waitcnt lgkmcnt(8)
    v_mfma_f32_16x16x32_bf16 v[136:139], v[24:27], v[92:95], v[136:139]
    ds_read_b128 v[104:107], v13 offset:4096
    s_waitcnt lgkmcnt(7)
    v_mfma_f32_16x16x32_bf16 v[136:139], v[40:43], v[96:99], v[136:139]
    ds_read_b128 v[88:91], v12 offset:6144
    v_mfma_f32_16x16x32_bf16 v[140:143], v[28:31], v[92:95], v[140:143]
    s_add_u32 m0, s89, 16384
    s_add_u32 s83, s64, 0
    v_mfma_f32_16x16x32_bf16 v[140:143], v[44:47], v[96:99], v[140:143]
    buffer_load_dwordx4 v3, s[12:15], s83 offen offset:1024 lds
    v_mfma_f32_16x16x32_bf16 v[200:203], v[32:35], v[92:95], v[200:203]
    v_add_u32 v116, s29, v116
    v_mfma_f32_16x16x32_bf16 v[200:203], v[48:51], v[96:99], v[200:203]
    s_waitcnt lgkmcnt(3)
    v_cmp_gt_u32 vcc, 4, v16
    v_mfma_f32_16x16x32_bf16 v[204:207], v[36:39], v[92:95], v[204:207]
    s_add_u32 m0, s89, 34816
    s_add_u32 s83, s28, 14336
    v_mfma_f32_16x16x32_bf16 v[204:207], v[52:55], v[96:99], v[204:207]
    buffer_load_dwordx4 v6, s[8:11], s83 offen offset:1024 lds
    s_waitcnt vmcnt(18) lgkmcnt(2)
    v_mfma_f32_16x16x32_bf16 v[144:147], v[24:27], v[100:103], v[144:147]
    ds_read_b128 v[92:95], v13 offset:6144
    s_cbranch_vccnz PG_4
PG_4_r:
    s_waitcnt lgkmcnt(2)
    v_mfma_f32_16x16x32_bf16 v[144:147], v[40:43], v[104:107], v[144:147]
    ds_read_b128 v[96:99], v12 offset:8192
    ds_read_b64_tr_b16 v[58:59], v125 offset:2048
    v_mfma_f32_16x16x32_bf16 v[148:151], v[28:31], v[100:103], v[148:151]
    s_movk_i32 s33, 3584
    v_mfma_f32_16x16x32_bf16 v[148:151], v[44:47], v[104:107], v[148:151]
    ds_read_b64_tr_b16 v[62:63], v15 offset:2048
    v_mfma_f32_16x16x32_bf16 v[208:211], v[32:35], v[100:103], v[208:211]
    s_movk_i32 s34, 7168
    v_mfma_f32_16x16x32_bf16 v[208:211], v[48:51], v[104:107], v[208:211]
    ds_read_b64_tr_b16 v[66:67], v125 offset:3072
    v_mfma_f32_16x16x32_bf16 v[212:215], v[36:39], v[100:103], v[212:215]
    s_add_u32 m0, s89, 18432
    s_add_u32 s83, s64, 14336
    v_mfma_f32_16x16x32_bf16 v[212:215], v[52:55], v[104:107], v[212:215]
    ds_read_b64_tr_b16 v[70:71], v15 offset:3072
    buffer_load_dwordx4 v2, s[12:15], s83 offen lds
    s_waitcnt lgkmcnt(6)
    v_mfma_f32_16x16x32_bf16 v[152:155], v[24:27], v[88:91], v[152:155]
    ds_read_b128 v[100:103], v13 offset:8192
    s_waitcnt lgkmcnt(6)
    v_mfma_f32_16x16x32_bf16 v[152:155], v[40:43], v[92:95], v[152:155]
    ds_read_b128 v[104:107], v12 offset:10240
    v_mfma_f32_16x16x32_bf16 v[156:159], v[28:31], v[88:91], v[156:159]
    s_add_u32 m0, s89, 18432
    s_add_u32 s83, s64, 14336
    v_mfma_f32_16x16x32_bf16 v[156:159], v[44:47], v[92:95], v[156:159]
    buffer_load_dwordx4 v3, s[12:15], s83 offen offset:1024 lds
    v_mfma_f32_16x16x32_bf16 v[216:219], v[32:35], v[88:91], v[216:219]
    s_movk_i32 s35, 10752
    v_mfma_f32_16x16x32_bf16 v[216:219], v[48:51], v[92:95], v[216:219]
    s_movk_i32 s36, 14336
    v_mfma_f32_16x16x32_bf16 v[220:223], v[36:39], v[88:91], v[220:223]
    s_add_u32 m0, s89, 49152
    s_add_u32 s83, s28, 28672
    v_mfma_f32_16x16x32_bf16 v[220:223], v[52:55], v[92:95], v[220:223]
    buffer_load_dwordx4 v5, s[8:11], s83 offen lds
    s_waitcnt vmcnt(19) lgkmcnt(2)
    v_mfma_f32_16x16x32_bf16 v[160:163], v[24:27], v[96:99], v[160:163]
    ds_read_b128 v[88:91], v13 offset:10240
    s_waitcnt lgkmcnt(2)
    v_mfma_f32_16x16x32_bf16 v[160:163], v[40:43], v[100:103], v[160:163]
    ds_read_b128 v[92:95], v12 offset:12288
    ds_read_b64_tr_b16 v[72:73], v9 offset:24576
    v_mfma_f32_16x16x32_bf16 v[164:167], v[28:31], v[96:99], v[164:167]
    s_movk_i32 s37, 17920
    v_mfma_f32_16x16x32_bf16 v[164:167], v[44:47], v[100:103], v[164:167]
    ds_read_b64_tr_b16 v[76:77], v14 offset:24576
    v_mfma_f32_16x16x32_bf16 v[224:227], v[32:35], v[96:99], v[224:227]
    s_movk_i32 s38, 21504
    v_mfma_f32_16x16x32_bf16 v[224:227], v[48:51], v[100:103], v[224:227]
    ds_read_b64_tr_b16 v[80:81], v9 offset:25600
    v_mfma_f32_16x16x32_bf16 v[228:231], v[36:39], v[96:99], v[228:231]
    s_add_u32 m0, s89, 2048
    s_add_u32 s83, s65, 0
    v_mfma_f32_16x16x32_bf16 v[228:231], v[52:55], v[100:103], v[228:231]
    ds_read_b64_tr_b16 v[84:85], v14 offset:25600
    buffer_load_dwordx4 v2, s[12:15], s83 offen lds
    s_waitcnt lgkmcnt(6)
    v_mfma_f32_16x16x32_bf16 v[168:171], v[24:27], v[104:107], v[168:171]
    ds_read_b128 v[96:99], v13 offset:12288
    s_waitcnt lgkmcnt(6)
    v_mfma_f32_16x16x32_bf16 v[168:171], v[40:43], v[88:91], v[168:171]
    ds_read_b128 v[100:103], v12 offset:14336
    v_mfma_f32_16x16x32_bf16 v[172:175], v[28:31], v[104:107], v[172:175]
    s_add_u32 m0, s89, 2048
    s_add_u32 s83, s65, 0
    v_mfma_f32_16x16x32_bf16 v[172:175], v[44:47], v[88:91], v[172:175]
    buffer_load_dwordx4 v3, s[12:15], s83 offen offset:1024 lds
    v_mfma_f32_16x16x32_bf16 v[232:235], v[32:35], v[104:107], v[232:235]
    s_movk_i32 s39, 25088
    v_mfma_f32_16x16x32_bf16 v[232:235], v[48:51], v[88:91], v[232:235]
    s_mul_i32 s40, s5, 7
    v_mfma_f32_16x16x32_bf16 v[236:239], v[36:39], v[104:107], v[236:239]
    s_add_u32 m0, s89, 49152
    s_add_u32 s83, s28, 28672
    v_mfma_f32_16x16x32_bf16 v[236:239], v[52:55], v[88:91], v[236:239]
    buffer_load_dwordx4 v6, s[8:11], s83 offen offset:1024 lds
    s_waitcnt vmcnt(20) lgkmcnt(2)
    v_mfma_f32_16x16x32_bf16 v[176:179], v[24:27], v[92:95], v[176:179]
    ds_read_b128 v[104:107], v13 offset:14336
    s_waitcnt lgkmcnt(2)
    v_mfma_f32_16x16x32_bf16 v[176:179], v[40:43], v[96:99], v[176:179]
    ds_read_b128 v[88:91], v12 offset:16384
    ds_read_b64_tr_b16 v[74:75], v9 offset:32768
    v_mfma_f32_16x16x32_bf16 v[180:183], v[28:31], v[92:95], v[180:183]
    s_add_u32 s40, s40, s91
    v_mfma_f32_16x16x32_bf16 v[180:183], v[44:47], v[96:99], v[180:183]
    ds_read_b64_tr_b16 v[78:79], v14 offset:32768
    v_mfma_f32_16x16x32_bf16 v[240:243], v[32:35], v[92:95], v[240:243]
    s_lshl_b32 s40, s40, 1
    v_mfma_f32_16x16x32_bf16 v[240:243], v[48:51], v[96:99], v[240:243]
    ds_read_b64_tr_b16 v[82:83], v9 offset:33792
    v_mfma_f32_16x16x32_bf16 v[244:247], v[36:39], v[92:95], v[244:247]
    s_add_u32 m0, s79, 24576
    s_add_u32 s83, s65, 14336
    v_mfma_f32_16x16x32_bf16 v[244:247], v[52:55], v[96:99], v[244:247]
    ds_read_b64_tr_b16 v[86:87], v14 offset:33792
    buffer_load_dwordx4 v2, s[12:15], s83 offen lds
    s_waitcnt lgkmcnt(6)
    v_mfma_f32_16x16x32_bf16 v[184:187], v[24:27], v[100:103], v[184:187]
    ds_read_b128 v[92:95], v13 offset:16384
    s_waitcnt lgkmcnt(6)
    v_mfma_f32_16x16x32_bf16 v[184:187], v[40:43], v[104:107], v[184:187]
    ds_read_b128 v[96:99], v12 offset:18432
    v_mfma_f32_16x16x32_bf16 v[188:191], v[28:31], v[100:103], v[188:191]
    s_add_u32 m0, s79, 24576
    s_add_u32 s83, s65, 14336
    v_mfma_f32_16x16x32_bf16 v[188:191], v[44:47], v[104:107], v[188:191]
    buffer_load_dwordx4 v3, s[12:15], s83 offen offset:1024 lds
    v_mfma_f32_16x16x32_bf16 v[248:251], v[32:35], v[100:103], v[248:251]
    s_add_u32 s40, s40, s85
    v_mfma_f32_16x16x32_bf16 v[248:251], v[48:51], v[104:107], v[248:251]
    v_mov_b32 v126, 5
    ds_write_b32 v19, v126
    v_mfma_f32_16x16x32_bf16 v[252:255], v[36:39], v[100:103], v[252:255]
    s_add_u32 m0, s89, 51200
    s_add_u32 s83, s28, 43008
    v_mfma_f32_16x16x32_bf16 v[252:255], v[52:55], v[104:107], v[252:255]
    buffer_load_dwordx4 v5, s[8:11], s83 offen lds
    s_waitcnt vmcnt(21) lgkmcnt(3)
    v_mfma_f32_16x16x32_bf16 v[128:131], v[56:59], v[88:91], v[128:131]
    ds_read_b128 v[100:103], v13 offset:18432
    s_waitcnt lgkmcnt(3)
    v_mfma_f32_16x16x32_bf16 v[128:131], v[72:75], v[92:95], v[128:131]
    ds_read_b128 v[104:107], v12 offset:20480
    ds_read_b64_tr_b16 v[24:25], v9 offset:0
    v_mfma_f32_16x16x32_bf16 v[132:135], v[60:63], v[88:91], v[132:135]
    s_lshl_b32 s40, s40, 2
    v_mfma_f32_16x16x32_bf16 v[132:135], v[76:79], v[92:95], v[132:135]
    ds_read_b64_tr_b16 v[28:29], v14 offset:0
    v_mfma_f32_16x16x32_bf16 v[192:195], v[64:67], v[88:91], v[192:195]
    s_add_u32 s40, s40, s4
    v_mfma_f32_16x16x32_bf16 v[192:195], v[80:83], v[92:95], v[192:195]
    ds_read_b64_tr_b16 v[32:33], v9 offset:1024
    ds_read_b32 v16, v17
    v_mfma_f32_16x16x32_bf16 v[196:199], v[68:71], v[88:91], v[196:199]
    s_add_u32 m0, s79, 32768
    s_add_u32 s83, s66, 0
    v_mfma_f32_16x16x32_bf16 v[196:199], v[84:87], v[92:95], v[196:199]
    ds_read_b64_tr_b16 v[36:37], v14 offset:1024
    buffer_load_dwordx4 v2, s[12:15], s83 offen lds
    s_waitcnt lgkmcnt(8)
    v_mfma_f32_16x16x32_bf16 v[136:139], v[56:59], v[96:99], v[136:139]
    ds_read_b128 v[88:91], v13 offset:20480
    s_waitcnt lgkmcnt(7)
    v_mfma_f32_16x16x32_bf16 v[136:139], v[72:75], v[100:103], v[136:139]
    ds_read_b128 v[92:95], v12 offset:22528
    v_mfma_f32_16x16x32_bf16 v[140:143], v[60:63], v[96:99], v[140:143]
    s_add_u32 m0, s79, 32768
    s_add_u32 s83, s66, 0
    v_mfma_f32_16x16x32_bf16 v[140:143], v[76:79], v[100:103], v[140:143]
    buffer_load_dwordx4 v3, s[12:15], s83 offen offset:1024 lds
    v_mfma_f32_16x16x32_bf16 v[200:203], v[64:67], v[96:99], v[200:203]
    s_xor_b32 s41, s40, 4
    v_mfma_f32_16x16x32_bf16 v[200:203], v[80:83], v[100:103], v[200:203]
    s_waitcnt lgkmcnt(3)
    v_cmp_gt_u32 vcc, 5, v16
    v_mfma_f32_16x16x32_bf16 v[204:207], v[68:71], v[96:99], v[204:207]
    s_add_u32 m0, s89, 51200
    s_add_u32 s83, s28, 43008
    v_mfma_f32_16x16x32_bf16 v[204:207], v[84:87], v[100:103], v[204:207]
    buffer_load_dwordx4 v6, s[8:11], s83 offen offset:1024 lds
    s_waitcnt vmcnt(22) lgkmcnt(2)
    v_mfma_f32_16x16x32_bf16 v[144:147], v[56:59], v[104:107], v[144:147]
    ds_read_b128 v[96:99], v13 offset:22528
    s_cbranch_vccnz PG_5
PG_5_r:
    s_waitcnt lgkmcnt(2)
    v_mfma_f32_16x16x32_bf16 v[144:147], v[72:75], v[88:91], v[144:147]
    ds_read_b128 v[100:103], v12 offset:24576
    ds_read_b64_tr_b16 v[26:27], v9 offset:8192
    v_mfma_f32_16x16x32_bf16 v[148:151], v[60:63], v[104:107], v[148:151]
    s_mul_i32 s40, s40, 3072
    v_mfma_f32_16x16x32_bf16 v[148:151], v[76:79], v[88:91], v[148:151]
    ds_read_b64_tr_b16 v[30:31], v14 offset:8192
    v_mfma_f32_16x16x32_bf16 v[208:211], v[64:67], v[104:107], v[208:211]
    s_mul_i32 s41, s41, 3072
    v_mfma_f32_16x16x32_bf16 v[208:211], v[80:83], v[88:91], v[208:211]
    ds_read_b64_tr_b16 v[34:35], v9 offset:9216
    v_mfma_f32_16x16x32_bf16 v[212:215], v[68:71], v[104:107], v[212:215]
    s_add_u32 m0, s79, 0
    s_add_u32 s83, s66, 14336
    v_mfma_f32_16x16x32_bf16 v[212:215], v[84:87], v[88:91], v[212:215]
    ds_read_b64_tr_b16 v[38:39], v14 offset:9216
    buffer_load_dwordx4 v2, s[12:15], s83 offen lds
    s_waitcnt lgkmcnt(6)
    v_mfma_f32_16x16x32_bf16 v[152:155], v[56:59], v[92:95], v[152:155]
    ds_read_b128 v[104:107], v13 offset:24576
    s_waitcnt lgkmcnt(6)
    v_mfma_f32_16x16x32_bf16 v[152:155], v[72:75], v[96:99], v[152:155]
    ds_read_b128 v[88:91], v12 offset:26624
    v_mfma_f32_16x16x32_bf16 v[156:159], v[60:63], v[92:95], v[156:159]
    s_add_u32 m0, s79, 0
    s_add_u32 s83, s66, 14336
    v_mfma_f32_16x16x32_bf16 v[156:159], v[76:79], v[96:99], v[156:159]
    buffer_load_dwordx4 v3, s[12:15], s83 offen offset:1024 lds
    v_mfma_f32_16x16x32_bf16 v[216:219], v[64:67], v[92:95], v[216:219]
    s_add_u32 s40, s40, 13762560
    v_mfma_f32_16x16x32_bf16 v[216:219], v[80:83], v[96:99], v[216:219]
    s_add_u32 s41, s41, 13762560
    v_mfma_f32_16x16x32_bf16 v[220:223], v[68:71], v[92:95], v[220:223]
    s_add_u32 m0, s89, 65536
    s_add_u32 s83, s94, 0
    v_mfma_f32_16x16x32_bf16 v[220:223], v[84:87], v[96:99], v[220:223]
    buffer_load_dwordx4 v5, s[8:11], s83 offen lds
    s_waitcnt vmcnt(22) lgkmcnt(2)
    v_mfma_f32_16x16x32_bf16 v[160:163], v[56:59], v[100:103], v[160:163]
    ds_read_b128 v[92:95], v13 offset:26624
    s_waitcnt lgkmcnt(2)
    v_mfma_f32_16x16x32_bf16 v[160:163], v[72:75], v[104:107], v[160:163]
    ds_read_b128 v[96:99], v12 offset:28672
    ds_read_b64_tr_b16 v[40:41], v9 offset:16384
    v_mfma_f32_16x16x32_bf16 v[164:167], v[60:63], v[100:103], v[164:167]
    v_mfma_f32_16x16x32_bf16 v[164:167], v[76:79], v[104:107], v[164:167]
    ds_read_b64_tr_b16 v[44:45], v14 offset:16384
    v_mfma_f32_16x16x32_bf16 v[224:227], v[64:67], v[100:103], v[224:227]
    v_mfma_f32_16x16x32_bf16 v[224:227], v[80:83], v[104:107], v[224:227]
    ds_read_b64_tr_b16 v[48:49], v9 offset:17408
    v_mfma_f32_16x16x32_bf16 v[228:231], v[68:71], v[100:103], v[228:231]
    s_add_u32 m0, s79, 8192
    s_add_u32 s83, s67, 0
    v_mfma_f32_16x16x32_bf16 v[228:231], v[84:87], v[104:107], v[228:231]
    ds_read_b64_tr_b16 v[52:53], v14 offset:17408
    buffer_load_dwordx4 v2, s[12:15], s83 offen lds
    s_waitcnt lgkmcnt(6)
    v_mfma_f32_16x16x32_bf16 v[168:171], v[56:59], v[88:91], v[168:171]
    ds_read_b128 v[100:103], v13 offset:28672
    s_waitcnt lgkmcnt(6)
    v_mfma_f32_16x16x32_bf16 v[168:171], v[72:75], v[92:95], v[168:171]
    ds_read_b128 v[104:107], v12 offset:30720
    v_mfma_f32_16x16x32_bf16 v[172:175], v[60:63], v[88:91], v[172:175]
    s_add_u32 m0, s79, 8192
    s_add_u32 s83, s67, 0
    v_mfma_f32_16x16x32_bf16 v[172:175], v[76:79], v[92:95], v[172:175]
    buffer_load_dwordx4 v3, s[12:15], s83 offen offset:1024 lds
    v_mfma_f32_16x16x32_bf16 v[232:235], v[64:67], v[88:91], v[232:235]
    v_mfma_f32_16x16x32_bf16 v[232:235], v[80:83], v[92:95], v[232:235]
    v_mfma_f32_16x16x32_bf16 v[236:239], v[68:71], v[88:91], v[236:239]
    s_add_u32 m0, s89, 65536
    s_add_u32 s83, s94, 0
    v_mfma_f32_16x16x32_bf16 v[236:239], v[84:87], v[92:95], v[236:239]
    buffer_load_dwordx4 v6, s[8:11], s83 offen offset:1024 lds
    s_waitcnt vmcnt(22) lgkmcnt(2)
    v_mfma_f32_16x16x32_bf16 v[176:179], v[56:59], v[96:99], v[176:179]
    ds_read_b128 v[88:91], v13 offset:30720
    s_waitcnt lgkmcnt(2)
    v_mfma_f32_16x16x32_bf16 v[176:179], v[72:75], v[100:103], v[176:179]
    ds_read_b128 v[92:95], v12 offset:32768
    ds_read_b64_tr_b16 v[42:43], v125 offset:0
    v_mfma_f32_16x16x32_bf16 v[180:183], v[60:63], v[96:99], v[180:183]
    v_mfma_f32_16x16x32_bf16 v[180:183], v[76:79], v[100:103], v[180:183]
    ds_read_b64_tr_b16 v[46:47], v15 offset:0
    v_mfma_f32_16x16x32_bf16 v[240:243], v[64:67], v[96:99], v[240:243]
    v_mfma_f32_16x16x32_bf16 v[240:243], v[80:83], v[100:103], v[240:243]
    ds_read_b64_tr_b16 v[50:51], v125 offset:1024
    v_mfma_f32_16x16x32_bf16 v[244:247], v[68:71], v[96:99], v[244:247]
    s_add_u32 m0, s79, 16384
    s_add_u32 s83, s67, 14336
    v_mfma_f32_16x16x32_bf16 v[244:247], v[84:87], v[100:103], v[244:247]
    ds_read_b64_tr_b16 v[54:55], v15 offset:1024
    buffer_load_dwordx4 v2, s[12:15], s83 offen lds
    s_waitcnt lgkmcnt(6)
    v_mfma_f32_16x16x32_bf16 v[184:187], v[56:59], v[104:107], v[184:187]
    ds_read_b128 v[96:99], v13 offset:32768
    s_waitcnt lgkmcnt(6)
    v_mfma_f32_16x16x32_bf16 v[184:187], v[72:75], v[88:91], v[184:187]
    ds_read_b128 v[100:103], v12 offset:34816
    v_mfma_f32_16x16x32_bf16 v[188:191], v[60:63], v[104:107], v[188:191]
    s_add_u32 m0, s79, 16384
    s_add_u32 s83, s67, 14336
    v_mfma_f32_16x16x32_bf16 v[188:191], v[76:79], v[88:91], v[188:191]
    buffer_load_dwordx4 v3, s[12:15], s83 offen offset:1024 lds
    v_mfma_f32_16x16x32_bf16 v[248:251], v[64:67], v[104:107], v[248:251]
    v_mfma_f32_16x16x32_bf16 v[248:251], v[80:83], v[88:91], v[248:251]
    s_waitcnt vmcnt(8)
    v_mov_b32 v126, 6
    ds_write_b32 v19, v126
    v_mfma_f32_16x16x32_bf16 v[252:255], v[68:71], v[104:107], v[252:255]
    s_add_u32 m0, s89, 67584
    s_add_u32 s83, s94, 14336
    v_mfma_f32_16x16x32_bf16 v[252:255], v[84:87], v[88:91], v[252:255]
    buffer_load_dwordx4 v5, s[8:11], s83 offen lds
    s_waitcnt lgkmcnt(3)
    v_mfma_f32_16x16x32_bf16 v[128:131], v[24:27], v[92:95], v[128:131]
    ds_read_b128 v[104:107], v13 offset:34816
    ds_read_b32 v121, v19 offset:16
    s_waitcnt lgkmcnt(4)
    v_mfma_f32_16x16x32_bf16 v[128:131], v[40:43], v[96:99], v[128:131]
    ds_read_b128 v[88:91], v12 offset:36864
    ds_read_b32 v72, v123 offset:0
    v_mfma_f32_16x16x32_bf16 v[132:135], v[28:31], v[92:95], v[132:135]
    ds_read_b32 v73, v123 offset:32
    ds_read_b32 v74, v123 offset:128
    v_mfma_f32_16x16x32_bf16 v[132:135], v[44:47], v[96:99], v[132:135]
    ds_read_b32 v75, v123 offset:160
    ds_read_b32 v76, v123 offset:256
    v_mfma_f32_16x16x32_bf16 v[192:195], v[32:35], v[92:95], v[192:195]
    ds_read_b32 v77, v123 offset:288
    ds_read_b32 v78, v123 offset:384
    v_mfma_f32_16x16x32_bf16 v[192:195], v[48:51], v[96:99], v[192:195]
    ds_read_b32 v79, v123 offset:416
    ds_read_b128 v[56:59], v122 offset:0
    v_mfma_f32_16x16x32_bf16 v[196:199], v[36:39], v[92:95], v[196:199]
    ds_read_b128 v[60:63], v122 offset:64
    ds_read_b128 v[64:67], v122 offset:128
    v_mfma_f32_16x16x32_bf16 v[196:199], v[52:55], v[96:99], v[196:199]
    ds_read_b128 v[68:71], v122 offset:192
    ds_read_b32 v16, v17
    s_waitcnt lgkmcnt(15)
    v_mfma_f32_16x16x32_bf16 v[136:139], v[24:27], v[100:103], v[136:139]
    ds_read_b128 v[92:95], v13 offset:36864
    v_mfma_f32_16x16x32_bf16 v[136:139], v[40:43], v[104:107], v[136:139]
    ds_read_b128 v[96:99], v12 offset:38912
    v_mfma_f32_16x16x32_bf16 v[140:143], v[28:31], v[100:103], v[140:143]
    s_add_u32 m0, s89, 0
    s_add_u32 s83, s68, 0
    v_mfma_f32_16x16x32_bf16 v[140:143], v[44:47], v[104:107], v[140:143]
    buffer_load_dwordx4 v2, s[12:15], s83 offen lds
    v_mfma_f32_16x16x32_bf16 v[200:203], v[32:35], v[100:103], v[200:203]
    s_add_u32 m0, s89, 0
    s_add_u32 s83, s68, 0
    v_mfma_f32_16x16x32_bf16 v[200:203], v[48:51], v[104:107], v[200:203]
    buffer_load_dwordx4 v3, s[12:15], s83 offen offset:1024 lds
    v_mfma_f32_16x16x32_bf16 v[204:207], v[36:39], v[100:103], v[204:207]
    s_waitcnt lgkmcnt(3)
    v_readfirstlane_b32 s97, v121
    s_cmp_eq_u32 s97, 0
    s_cbranch_scc1 K_csslow
K_csok:
    v_mfma_f32_16x16x32_bf16 v[204:207], v[52:55], v[104:107], v[204:207]
    s_waitcnt lgkmcnt(2)
    v_cmp_gt_u32 vcc, 6, v16
    s_add_u32 m0, s89, 67584
    s_add_u32 s83, s94, 14336
    buffer_load_dwordx4 v6, s[8:11], s83 offen offset:1024 lds
    v_mfma_f32_16x16x32_bf16 v[144:147], v[24:27], v[88:91], v[144:147]
    ds_read_b128 v[100:103], v13 offset:38912
    s_cbranch_vccnz PG_6
PG_6_r:
    v_fma_f32 v128, -v56, v72, v128
    s_waitcnt lgkmcnt(2)
    v_mfma_f32_16x16x32_bf16 v[144:147], v[40:43], v[92:95], v[144:147]
    ds_read_b128 v[104:107], v12 offset:40960
    v_fma_f32 v192, -v64, v72, v192
    v_fma_f32 v129, -v57, v72, v129
    v_mfma_f32_16x16x32_bf16 v[148:151], v[28:31], v[88:91], v[148:151]
    v_fma_f32 v193, -v65, v72, v193
    v_fma_f32 v130, -v58, v72, v130
    v_fma_f32 v194, -v66, v72, v194
    v_mfma_f32_16x16x32_bf16 v[148:151], v[44:47], v[92:95], v[148:151]
    v_fma_f32 v131, -v59, v72, v131
    v_fma_f32 v195, -v67, v72, v195
    v_fma_f32 v132, -v60, v72, v132
    v_mfma_f32_16x16x32_bf16 v[208:211], v[32:35], v[88:91], v[208:211]
    v_fma_f32 v196, -v68, v72, v196
    v_fma_f32 v133, -v61, v72, v133
    v_fma_f32 v197, -v69, v72, v197
    v_mfma_f32_16x16x32_bf16 v[208:211], v[48:51], v[92:95], v[208:211]
    v_fma_f32 v134, -v62, v72, v134
    v_fma_f32 v198, -v70, v72, v198
    v_fma_f32 v135, -v63, v72, v135
    v_mfma_f32_16x16x32_bf16 v[212:215], v[36:39], v[88:91], v[212:215]
    s_add_u32 m0, s89, 81920
    s_add_u32 s83, s94, 28672
    v_fma_f32 v199, -v71, v72, v199
    v_mfma_f32_16x16x32_bf16 v[212:215], v[52:55], v[92:95], v[212:215]
    buffer_load_dwordx4 v5, s[8:11], s83 offen lds
    v_max_f32 v128, 0, v128
    v_max_f32 v129, 0, v129
    s_waitcnt lgkmcnt(2)
    v_mfma_f32_16x16x32_bf16 v[152:155], v[24:27], v[96:99], v[152:155]
    ds_read_b128 v[88:91], v13 offset:40960
    v_max_f32 v130, 0, v130
    v_max_f32 v131, 0, v131
    s_waitcnt lgkmcnt(2)
    v_mfma_f32_16x16x32_bf16 v[152:155], v[40:43], v[100:103], v[152:155]
    ds_read_b128 v[92:95], v12 offset:43008
    v_max_f32 v132, 0, v132
    v_max_f32 v133, 0, v133
    v_mfma_f32_16x16x32_bf16 v[156:159], v[28:31], v[96:99], v[156:159]
    v_max_f32 v134, 0, v134
    v_max_f32 v135, 0, v135
    v_mul_f32 v128, v128, v192
    v_mfma_f32_16x16x32_bf16 v[156:159], v[44:47], v[100:103], v[156:159]
    v_mul_f32 v129, v129, v193
    v_mul_f32 v130, v130, v194
    v_mul_f32 v131, v131, v195
    v_mfma_f32_16x16x32_bf16 v[216:219], v[32:35], v[96:99], v[216:219]
    v_mul_f32 v132, v132, v196
    v_mul_f32 v133, v133, v197
    v_mul_f32 v134, v134, v198
    v_mfma_f32_16x16x32_bf16 v[216:219], v[48:51], v[100:103], v[216:219]
    v_mul_f32 v135, v135, v199
    v_cvt_pk_bf16_f32 v192, v128, v129
    v_cvt_pk_bf16_f32 v193, v130, v131
    v_mfma_f32_16x16x32_bf16 v[220:223], v[36:39], v[96:99], v[220:223]
    s_add_u32 m0, s89, 81920
    s_add_u32 s83, s94, 28672
    v_cvt_pk_bf16_f32 v194, v132, v133
    v_mfma_f32_16x16x32_bf16 v[220:223], v[52:55], v[100:103], v[220:223]
    buffer_load_dwordx4 v6, s[8:11], s83 offen offset:1024 lds
    v_cvt_pk_bf16_f32 v195, v134, v135
    buffer_store_dwordx4 v[192:195], v18, s[20:23], s86 offen offset:0 sc1
    s_waitcnt lgkmcnt(2)
    v_mfma_f32_16x16x32_bf16 v[160:163], v[24:27], v[104:107], v[160:163]
    ds_read_b128 v[96:99], v13 offset:43008
    v_fma_f32 v136, -v56, v73, v136
    v_fma_f32 v200, -v64, v73, v200
    s_waitcnt lgkmcnt(2)
    v_mfma_f32_16x16x32_bf16 v[160:163], v[40:43], v[88:91], v[160:163]
    ds_read_b128 v[100:103], v12 offset:45056
    v_fma_f32 v137, -v57, v73, v137
    v_fma_f32 v201, -v65, v73, v201
    v_mfma_f32_16x16x32_bf16 v[164:167], v[28:31], v[104:107], v[164:167]
    v_fma_f32 v138, -v58, v73, v138
    v_fma_f32 v202, -v66, v73, v202
    v_fma_f32 v139, -v59, v73, v139
    v_mfma_f32_16x16x32_bf16 v[164:167], v[44:47], v[88:91], v[164:167]
    v_fma_f32 v203, -v67, v73, v203
    v_fma_f32 v140, -v60, v73, v140
    v_fma_f32 v204, -v68, v73, v204
    v_mfma_f32_16x16x32_bf16 v[224:227], v[32:35], v[104:107], v[224:227]
    v_fma_f32 v141, -v61, v73, v141
    v_fma_f32 v205, -v69, v73, v205
    v_fma_f32 v142, -v62, v73, v142
    v_mfma_f32_16x16x32_bf16 v[224:227], v[48:51], v[88:91], v[224:227]
    v_fma_f32 v206, -v70, v73, v206
    v_fma_f32 v143, -v63, v73, v143
    v_fma_f32 v207, -v71, v73, v207
    v_mfma_f32_16x16x32_bf16 v[228:231], v[36:39], v[104:107], v[228:231]
    s_add_u32 m0, s89, 83968
    s_add_u32 s83, s94, 43008
    v_max_f32 v136, 0, v136
    v_mfma_f32_16x16x32_bf16 v[228:231], v[52:55], v[88:91], v[228:231]
    buffer_load_dwordx4 v5, s[8:11], s83 offen lds
    v_max_f32 v137, 0, v137
    v_max_f32 v138, 0, v138
    s_waitcnt lgkmcnt(2)
    v_mfma_f32_16x16x32_bf16 v[168:171], v[24:27], v[92:95], v[168:171]
    ds_read_b128 v[104:107], v13 offset:45056
    v_max_f32 v139, 0, v139
    v_max_f32 v140, 0, v140
    s_waitcnt lgkmcnt(2)
    v_mfma_f32_16x16x32_bf16 v[168:171], v[40:43], v[96:99], v[168:171]
    ds_read_b128 v[88:91], v12 offset:47104
    v_max_f32 v141, 0, v141
    v_max_f32 v142, 0, v142
    v_mfma_f32_16x16x32_bf16 v[172:175], v[28:31], v[92:95], v[172:175]
    v_max_f32 v143, 0, v143
    v_mul_f32 v136, v136, v200
    v_mul_f32 v137, v137, v201
    v_mfma_f32_16x16x32_bf16 v[172:175], v[44:47], v[96:99], v[172:175]
    v_mul_f32 v138, v138, v202
    v_mul_f32 v139, v139, v203
    v_mul_f32 v140, v140, v204
    v_mfma_f32_16x16x32_bf16 v[232:235], v[32:35], v[92:95], v[232:235]
    v_mul_f32 v141, v141, v205
    v_mul_f32 v142, v142, v206
    v_mul_f32 v143, v143, v207
    v_mfma_f32_16x16x32_bf16 v[232:235], v[48:51], v[96:99], v[232:235]
    v_cvt_pk_bf16_f32 v200, v136, v137
    v_cvt_pk_bf16_f32 v201, v138, v139
    v_cvt_pk_bf16_f32 v202, v140, v141
    v_mfma_f32_16x16x32_bf16 v[236:239], v[36:39], v[92:95], v[236:239]
    s_add_u32 m0, s89, 83968
    s_add_u32 s83, s94, 43008
    v_cvt_pk_bf16_f32 v203, v142, v143
    v_mfma_f32_16x16x32_bf16 v[236:239], v[52:55], v[96:99], v[236:239]
    buffer_load_dwordx4 v6, s[8:11], s83 offen offset:1024 lds
    buffer_store_dwordx4 v[200:203], v18, s[20:23], s86 offen offset:1024 sc1
    s_waitcnt lgkmcnt(2)
    v_mfma_f32_16x16x32_bf16 v[176:179], v[24:27], v[100:103], v[176:179]
    ds_read_b128 v[92:95], v13 offset:47104
    v_fma_f32 v144, -v56, v74, v144
    v_fma_f32 v208, -v64, v74, v208
    s_waitcnt lgkmcnt(2)
    v_mfma_f32_16x16x32_bf16 v[176:179], v[40:43], v[104:107], v[176:179]
    v_fma_f32 v145, -v57, v74, v145
    v_fma_f32 v209, -v65, v74, v209
    v_fma_f32 v146, -v58, v74, v146
    v_mfma_f32_16x16x32_bf16 v[180:183], v[28:31], v[100:103], v[180:183]
    v_fma_f32 v210, -v66, v74, v210
    v_fma_f32 v147, -v59, v74, v147
    v_fma_f32 v211, -v67, v74, v211
    v_mfma_f32_16x16x32_bf16 v[180:183], v[44:47], v[104:107], v[180:183]
    v_fma_f32 v148, -v60, v74, v148
    v_fma_f32 v212, -v68, v74, v212
    v_fma_f32 v149, -v61, v74, v149
    v_mfma_f32_16x16x32_bf16 v[240:243], v[32:35], v[100:103], v[240:243]
    v_fma_f32 v213, -v69, v74, v213
    v_fma_f32 v150, -v62, v74, v150
    v_fma_f32 v214, -v70, v74, v214
    v_mfma_f32_16x16x32_bf16 v[240:243], v[48:51], v[104:107], v[240:243]
    v_fma_f32 v151, -v63, v74, v151
    v_fma_f32 v215, -v71, v74, v215
    v_max_f32 v144, 0, v144
    v_mfma_f32_16x16x32_bf16 v[244:247], v[36:39], v[100:103], v[244:247]
    v_max_f32 v145, 0, v145
    v_max_f32 v146, 0, v146
    v_max_f32 v147, 0, v147
    v_mfma_f32_16x16x32_bf16 v[244:247], v[52:55], v[104:107], v[244:247]
    v_max_f32 v148, 0, v148
    v_max_f32 v149, 0, v149
    v_max_f32 v150, 0, v150
    s_waitcnt lgkmcnt(1)
    v_mfma_f32_16x16x32_bf16 v[184:187], v[24:27], v[88:91], v[184:187]
    v_max_f32 v151, 0, v151
    v_mul_f32 v144, v144, v208
    v_mul_f32 v145, v145, v209
    s_waitcnt lgkmcnt(0)
    v_mfma_f32_16x16x32_bf16 v[184:187], v[40:43], v[92:95], v[184:187]
    v_mul_f32 v146, v146, v210
    v_mul_f32 v147, v147, v211
    v_mul_f32 v148, v148, v212
    v_mfma_f32_16x16x32_bf16 v[188:191], v[28:31], v[88:91], v[188:191]
    v_mul_f32 v149, v149, v213
    v_mul_f32 v150, v150, v214
    v_mul_f32 v151, v151, v215
    v_mfma_f32_16x16x32_bf16 v[188:191], v[44:47], v[92:95], v[188:191]
    v_cvt_pk_bf16_f32 v208, v144, v145
    v_cvt_pk_bf16_f32 v209, v146, v147
    v_cvt_pk_bf16_f32 v210, v148, v149
    v_mfma_f32_16x16x32_bf16 v[248:251], v[32:35], v[88:91], v[248:251]
    v_cvt_pk_bf16_f32 v211, v150, v151
    buffer_store_dwordx4 v[208:211], v18, s[20:23], s86 offen offset:2048 sc1
    v_mfma_f32_16x16x32_bf16 v[248:251], v[48:51], v[92:95], v[248:251]
    v_mov_b32 v126, 7
    ds_write_b32 v19, v126
    v_mfma_f32_16x16x32_bf16 v[252:255], v[36:39], v[88:91], v[252:255]
    v_mfma_f32_16x16x32_bf16 v[252:255], v[52:55], v[92:95], v[252:255]
    v_pk_fma_f32 v[152:153], v[56:57], v[74:75], v[152:153] op_sel:[0,1,0] op_sel_hi:[1,1,1] neg_lo:[1,0,0] neg_hi:[1,0,0]
    v_pk_fma_f32 v[216:217], v[64:65], v[74:75], v[216:217] op_sel:[0,1,0] op_sel_hi:[1,1,1] neg_lo:[1,0,0] neg_hi:[1,0,0]
    v_pk_fma_f32 v[154:155], v[58:59], v[74:75], v[154:155] op_sel:[0,1,0] op_sel_hi:[1,1,1] neg_lo:[1,0,0] neg_hi:[1,0,0]
    v_pk_fma_f32 v[218:219], v[66:67], v[74:75], v[218:219] op_sel:[0,1,0] op_sel_hi:[1,1,1] neg_lo:[1,0,0] neg_hi:[1,0,0]
    v_pk_fma_f32 v[156:157], v[60:61], v[74:75], v[156:157] op_sel:[0,1,0] op_sel_hi:[1,1,1] neg_lo:[1,0,0] neg_hi:[1,0,0]
    v_pk_fma_f32 v[220:221], v[68:69], v[74:75], v[220:221] op_sel:[0,1,0] op_sel_hi:[1,1,1] neg_lo:[1,0,0] neg_hi:[1,0,0]
    v_pk_fma_f32 v[158:159], v[62:63], v[74:75], v[158:159] op_sel:[0,1,0] op_sel_hi:[1,1,1] neg_lo:[1,0,0] neg_hi:[1,0,0]
    v_pk_fma_f32 v[222:223], v[70:71], v[74:75], v[222:223] op_sel:[0,1,0] op_sel_hi:[1,1,1] neg_lo:[1,0,0] neg_hi:[1,0,0]
    v_max_f32 v152, 0, v152
    v_max_f32 v153, 0, v153
    v_max_f32 v154, 0, v154
    v_max_f32 v155, 0, v155
    v_max_f32 v156, 0, v156
    v_max_f32 v157, 0, v157
    v_max_f32 v158, 0, v158
    v_max_f32 v159, 0, v159
    v_pk_mul_f32 v[152:153], v[152:153], v[216:217]
    v_pk_mul_f32 v[154:155], v[154:155], v[218:219]
    v_pk_mul_f32 v[156:157], v[156:157], v[220:221]
    v_pk_mul_f32 v[158:159], v[158:159], v[222:223]
    v_cvt_pk_bf16_f32 v216, v152, v153
    v_cvt_pk_bf16_f32 v217, v154, v155
    v_cvt_pk_bf16_f32 v218, v156, v157
    v_cvt_pk_bf16_f32 v219, v158, v159
    buffer_store_dwordx4 v[216:219], v18, s[20:23], s86 offen offset:3072 sc1
    v_pk_fma_f32 v[160:161], v[56:57], v[76:77], v[160:161] op_sel_hi:[1,0,1] neg_lo:[1,0,0] neg_hi:[1,0,0]
    v_pk_fma_f32 v[224:225], v[64:65], v[76:77], v[224:225] op_sel_hi:[1,0,1] neg_lo:[1,0,0] neg_hi:[1,0,0]
    v_pk_fma_f32 v[162:163], v[58:59], v[76:77], v[162:163] op_sel_hi:[1,0,1] neg_lo:[1,0,0] neg_hi:[1,0,0]
    v_pk_fma_f32 v[226:227], v[66:67], v[76:77], v[226:227] op_sel_hi:[1,0,1] neg_lo:[1,0,0] neg_hi:[1,0,0]
    v_pk_fma_f32 v[164:165], v[60:61], v[76:77], v[164:165] op_sel_hi:[1,0,1] neg_lo:[1,0,0] neg_hi:[1,0,0]
    v_pk_fma_f32 v[228:229], v[68:69], v[76:77], v[228:229] op_sel_hi:[1,0,1] neg_lo:[1,0,0] neg_hi:[1,0,0]
    v_pk_fma_f32 v[166:167], v[62:63], v[76:77], v[166:167] op_sel_hi:[1,0,1] neg_lo:[1,0,0] neg_hi:[1,0,0]
    v_pk_fma_f32 v[230:231], v[70:71], v[76:77], v[230:231] op_sel_hi:[1,0,1] neg_lo:[1,0,0] neg_hi:[1,0,0]
    v_max_f32 v160, 0, v160
    v_max_f32 v161, 0, v161
    v_max_f32 v162, 0, v162
    v_max_f32 v163, 0, v163
    v_max_f32 v164, 0, v164
    v_max_f32 v165, 0, v165
    v_max_f32 v166, 0, v166
    v_max_f32 v167, 0, v167
    v_pk_mul_f32 v[160:161], v[160:161], v[224:225]
    v_pk_mul_f32 v[162:163], v[162:163], v[226:227]
    v_pk_mul_f32 v[164:165], v[164:165], v[228:229]
    v_pk_mul_f32 v[166:167], v[166:167], v[230:231]
    v_cvt_pk_bf16_f32 v224, v160, v161
    v_cvt_pk_bf16_f32 v225, v162, v163
    v_cvt_pk_bf16_f32 v226, v164, v165
    v_cvt_pk_bf16_f32 v227, v166, v167
    buffer_store_dwordx4 v[224:227], v18, s[20:23], s87 offen offset:0 sc1
    v_pk_fma_f32 v[168:169], v[56:57], v[76:77], v[168:169] op_sel:[0,1,0] op_sel_hi:[1,1,1] neg_lo:[1,0,0] neg_hi:[1,0,0]
    v_pk_fma_f32 v[232:233], v[64:65], v[76:77], v[232:233] op_sel:[0,1,0] op_sel_hi:[1,1,1] neg_lo:[1,0,0] neg_hi:[1,0,0]
    v_pk_fma_f32 v[170:171], v[58:59], v[76:77], v[170:171] op_sel:[0,1,0] op_sel_hi:[1,1,1] neg_lo:[1,0,0] neg_hi:[1,0,0]
    v_pk_fma_f32 v[234:235], v[66:67], v[76:77], v[234:235] op_sel:[0,1,0] op_sel_hi:[1,1,1] neg_lo:[1,0,0] neg_hi:[1,0,0]
    v_pk_fma_f32 v[172:173], v[60:61], v[76:77], v[172:173] op_sel:[0,1,0] op_sel_hi:[1,1,1] neg_lo:[1,0,0] neg_hi:[1,0,0]
    v_pk_fma_f32 v[236:237], v[68:69], v[76:77], v[236:237] op_sel:[0,1,0] op_sel_hi:[1,1,1] neg_lo:[1,0,0] neg_hi:[1,0,0]
    v_pk_fma_f32 v[174:175], v[62:63], v[76:77], v[174:175] op_sel:[0,1,0] op_sel_hi:[1,1,1] neg_lo:[1,0,0] neg_hi:[1,0,0]
    v_pk_fma_f32 v[238:239], v[70:71], v[76:77], v[238:239] op_sel:[0,1,0] op_sel_hi:[1,1,1] neg_lo:[1,0,0] neg_hi:[1,0,0]
    v_max_f32 v168, 0, v168
    v_max_f32 v169, 0, v169
    v_max_f32 v170, 0, v170
    v_max_f32 v171, 0, v171
    v_max_f32 v172, 0, v172
    v_max_f32 v173, 0, v173
    v_max_f32 v174, 0, v174
    v_max_f32 v175, 0, v175
    v_pk_mul_f32 v[168:169], v[168:169], v[232:233]
    v_pk_mul_f32 v[170:171], v[170:171], v[234:235]
    v_pk_mul_f32 v[172:173], v[172:173], v[236:237]
    v_pk_mul_f32 v[174:175], v[174:175], v[238:239]
    v_cvt_pk_bf16_f32 v232, v168, v169
    v_cvt_pk_bf16_f32 v233, v170, v171
    v_cvt_pk_bf16_f32 v234, v172, v173
    v_cvt_pk_bf16_f32 v235, v174, v175
    buffer_store_dwordx4 v[232:235], v18, s[20:23], s87 offen offset:1024 sc1
    v_pk_fma_f32 v[176:177], v[56:57], v[78:79], v[176:177] op_sel_hi:[1,0,1] neg_lo:[1,0,0] neg_hi:[1,0,0]
    v_pk_fma_f32 v[240:241], v[64:65], v[78:79], v[240:241] op_sel_hi:[1,0,1] neg_lo:[1,0,0] neg_hi:[1,0,0]
    v_pk_fma_f32 v[178:179], v[58:59], v[78:79], v[178:179] op_sel_hi:[1,0,1] neg_lo:[1,0,0] neg_hi:[1,0,0]
    v_pk_fma_f32 v[242:243], v[66:67], v[78:79], v[242:243] op_sel_hi:[1,0,1] neg_lo:[1,0,0] neg_hi:[1,0,0]
    v_pk_fma_f32 v[180:181], v[60:61], v[78:79], v[180:181] op_sel_hi:[1,0,1] neg_lo:[1,0,0] neg_hi:[1,0,0]
    v_pk_fma_f32 v[244:245], v[68:69], v[78:79], v[244:245] op_sel_hi:[1,0,1] neg_lo:[1,0,0] neg_hi:[1,0,0]
    v_pk_fma_f32 v[182:183], v[62:63], v[78:79], v[182:183] op_sel_hi:[1,0,1] neg_lo:[1,0,0] neg_hi:[1,0,0]
    v_pk_fma_f32 v[246:247], v[70:71], v[78:79], v[246:247] op_sel_hi:[1,0,1] neg_lo:[1,0,0] neg_hi:[1,0,0]
    v_max_f32 v176, 0, v176
    v_max_f32 v177, 0, v177
    v_max_f32 v178, 0, v178
    v_max_f32 v179, 0, v179
    v_max_f32 v180, 0, v180
    v_max_f32 v181, 0, v181
    v_max_f32 v182, 0, v182
    v_max_f32 v183, 0, v183
    v_pk_mul_f32 v[176:177], v[176:177], v[240:241]
    v_pk_mul_f32 v[178:179], v[178:179], v[242:243]
    v_pk_mul_f32 v[180:181], v[180:181], v[244:245]
    v_pk_mul_f32 v[182:183], v[182:183], v[246:247]
    v_cvt_pk_bf16_f32 v240, v176, v177
    v_cvt_pk_bf16_f32 v241, v178, v179
    v_cvt_pk_bf16_f32 v242, v180, v181
    v_cvt_pk_bf16_f32 v243, v182, v183
    buffer_store_dwordx4 v[240:243], v18, s[20:23], s87 offen offset:2048 sc1
    ds_read_b32 v16, v17
    ds_read_b32 v121, v8 offset:88
    v_pk_fma_f32 v[184:185], v[56:57], v[78:79], v[184:185] op_sel:[0,1,0] op_sel_hi:[1,1,1] neg_lo:[1,0,0] neg_hi:[1,0,0]
    v_pk_fma_f32 v[248:249], v[64:65], v[78:79], v[248:249] op_sel:[0,1,0] op_sel_hi:[1,1,1] neg_lo:[1,0,0] neg_hi:[1,0,0]
    v_pk_fma_f32 v[186:187], v[58:59], v[78:79], v[186:187] op_sel:[0,1,0] op_sel_hi:[1,1,1] neg_lo:[1,0,0] neg_hi:[1,0,0]
    v_pk_fma_f32 v[250:251], v[66:67], v[78:79], v[250:251] op_sel:[0,1,0] op_sel_hi:[1,1,1] neg_lo:[1,0,0] neg_hi:[1,0,0]
    v_pk_fma_f32 v[188:189], v[60:61], v[78:79], v[188:189] op_sel:[0,1,0] op_sel_hi:[1,1,1] neg_lo:[1,0,0] neg_hi:[1,0,0]
    v_pk_fma_f32 v[252:253], v[68:69], v[78:79], v[252:253] op_sel:[0,1,0] op_sel_hi:[1,1,1] neg_lo:[1,0,0] neg_hi:[1,0,0]
    v_pk_fma_f32 v[190:191], v[62:63], v[78:79], v[190:191] op_sel:[0,1,0] op_sel_hi:[1,1,1] neg_lo:[1,0,0] neg_hi:[1,0,0]
    v_pk_fma_f32 v[254:255], v[70:71], v[78:79], v[254:255] op_sel:[0,1,0] op_sel_hi:[1,1,1] neg_lo:[1,0,0] neg_hi:[1,0,0]
    v_max_f32 v184, 0, v184
    v_max_f32 v185, 0, v185
    v_max_f32 v186, 0, v186
    v_max_f32 v187, 0, v187
    v_max_f32 v188, 0, v188
    v_max_f32 v189, 0, v189
    v_max_f32 v190, 0, v190
    v_max_f32 v191, 0, v191
    v_pk_mul_f32 v[184:185], v[184:185], v[248:249]
    v_pk_mul_f32 v[186:187], v[186:187], v[250:251]
    v_pk_mul_f32 v[188:189], v[188:189], v[252:253]
    v_pk_mul_f32 v[190:191], v[190:191], v[254:255]
    v_cvt_pk_bf16_f32 v248, v184, v185
    v_cvt_pk_bf16_f32 v249, v186, v187
    v_cvt_pk_bf16_f32 v250, v188, v189
    v_cvt_pk_bf16_f32 v251, v190, v191
    buffer_store_dwordx4 v[248:251], v18, s[20:23], s87 offen offset:3072 sc1
    s_waitcnt vmcnt(7)
    ds_write_b32 v19, v126 offset:32
    s_waitcnt lgkmcnt(1)
    v_cmp_gt_u32 vcc, 7, v16
    s_nop 4
    s_cbranch_vccnz PG_7
PG_7_r:
    v_readfirstlane_b32 s82, v121
    s_cmp_lt_u32 s82, 4
    s_cbranch_scc1 CP_8
CP_8_r:
    s_add_u32 s31, s89, 32768
    v_add_u32 v12, s31, v18
    ds_write_b128 v12, v[192:195] offset:0
    ds_write_b128 v12, v[200:203] offset:1024
    ds_write_b128 v12, v[208:211] offset:2048
    ds_write_b128 v12, v[216:219] offset:3072
    ds_write_b128 v12, v[224:227] offset:16384
    ds_write_b128 v12, v[232:235] offset:17408
    ds_write_b128 v12, v[240:243] offset:18432
    ds_write_b128 v12, v[248:251] offset:19456
    ds_write_b32 v19, v126 offset:160
    s_setprio 0
    ds_read_b128 v[88:91], v117 offset:512
    ds_read_b128 v[92:95], v117 offset:544
    s_and_b32 s31, s4, 1
    s_xor_b32 s30, s85, 1
    s_lshl_b32 s30, s30, 1
    s_add_u32 s31, s31, s30
    s_lshl_b32 s31, s31, 11
    v_add_u32 v10, s31, v18
    s_lshl_b32 s31, s91, 7
    s_lshl_b32 s30, s4, 2
    s_add_u32 s31, s31, s30
    v_mov_b32 v16, s31
    v_mov_b32 v17, s84
    v_and_b32 v14, 7, v0
    v_min_u32 v14, 6, v14
    v_lshlrev_b32 v14, 7, v14
    v_bfe_u32 v15, v0, 3, 1
    v_lshl_add_u32 v14, v15, 2, v14
    s_and_b32 s30, s30, 8
    v_add_u32 v14, s30, v14
    s_add_u32 s31, s89, 65536
    v_add_u32 v4, s31, v18
    v_xor_b32 v5, 0x2000, v4
    v_xor_b32 v6, 8, v19
    v_xor_b32 v9, 4, v19
    s_sub_u32 s31, s79, 16384
    v_add_u32 v7, s31, v18
    s_mov_b32 s16, s58
    s_and_b32 s17, s59, 0xffff
    s_mov_b32 s18, 3670016
    s_mov_b32 s19, 0x20000
    s_waitcnt lgkmcnt(0)
    v_mul_f32 v88, v88, v88
    v_mul_f32 v89, v89, v89
    v_mul_f32 v90, v90, v90
    v_mul_f32 v91, v91, v91
    v_mul_f32 v92, v92, v92
    v_mul_f32 v93, v93, v93
    v_mul_f32 v94, v94, v94
    v_mul_f32 v95, v95, v95
    s_and_b32 s30, s4, 2
    s_lshl_b32 s30, s30, 12
    s_and_b32 s31, s4, 1
    s_lshl_b32 s31, s31, 11
    s_add_u32 s30, s30, s31
    s_lshl_b32 s31, s85, 14
    s_add_u32 s30, s30, s31
    s_add_u32 s30, s30, 32768
    v_add_u32 v13, s30, v18
    v_xor_b32 v12, 0x4000, v13
    s_waitcnt vmcnt(0)
    s_mov_b64 exec, 1
    s_cmp_eq_u32 s97, 2
    s_cbranch_scc1 DS_9_l
    buffer_store_dword v17, v16, s[20:23], s93 offen sc1
    s_branch DS_9_e
DS_9_l:
    buffer_store_dword v17, v16, s[20:23], s93 offen
DS_9_e:
    s_mov_b64 exec, -1
    s_mov_b32 s95, 0
SP_10:
    ds_read_b32 v121, v9 offset:160
    ds_read_b128 v[56:59], v12 offset:0
    ds_read_b128 v[60:63], v12 offset:1024
    ds_read_b128 v[64:67], v13 offset:0
    ds_read_b128 v[68:71], v13 offset:1024
    ds_read_b128 v[72:75], v12 offset:4096
    ds_read_b128 v[76:79], v12 offset:5120
    ds_read_b128 v[80:83], v13 offset:4096
    ds_read_b128 v[84:87], v13 offset:5120
    s_waitcnt lgkmcnt(0)
    v_readfirstlane_b32 s82, v121
    s_cmp_lg_u32 s82, 0
    s_cbranch_scc1 SP_10_ok
    s_add_u32 s95, s95, 1
    s_cmp_lt_u32 s95, 2097152
    s_cbranch_scc1 SP_10
SP_10_ok:
    ds_write_b32 v19, v126 offset:176
    ds_read_b64_tr_b16 v[24:25], v108 offset:16384
    ds_read_b64_tr_b16 v[26:27], v108 offset:18432
    ds_read_b64_tr_b16 v[28:29], v109 offset:16384
    ds_read_b64_tr_b16 v[30:31], v109 offset:18432
    ds_read_b64_tr_b16 v[32:33], v110 offset:16384
    ds_read_b64_tr_b16 v[34:35], v110 offset:18432
    ds_read_b64_tr_b16 v[36:37], v111 offset:16384
    ds_read_b64_tr_b16 v[38:39], v111 offset:18432
    ds_read_b64_tr_b16 v[40:41], v108 offset:20480
    ds_read_b64_tr_b16 v[42:43], v108 offset:22528
    ds_read_b64_tr_b16 v[44:45], v109 offset:20480
    ds_read_b64_tr_b16 v[46:47], v109 offset:22528
    ds_read_b64_tr_b16 v[48:49], v110 offset:20480
    ds_read_b64_tr_b16 v[50:51], v110 offset:22528
    ds_read_b64_tr_b16 v[52:53], v111 offset:20480
    ds_read_b64_tr_b16 v[54:55], v111 offset:22528
    s_mov_b32 s95, 0
SP_11:
    ds_read_b32 v121, v9 offset:176
    s_waitcnt lgkmcnt(0)
    v_readfirstlane_b32 s82, v121
    s_cmp_lg_u32 s82, 0
    s_cbranch_scc1 SP_11_ok
    s_add_u32 s95, s95, 1
    s_cmp_lt_u32 s95, 2097152
    s_cbranch_scc1 SP_11
SP_11_ok:
    s_nop 1
    s_add_u32 m0, s79, -8192
    s_add_u32 s82, s68, 14336
    buffer_load_dwordx4 v2, s[12:15], s82 offen lds
    buffer_load_dwordx4 v3, s[12:15], s82 offen offset:1024 lds
    s_add_u32 m0, s89, 32768
    s_add_u32 s82, s69, 0
    buffer_load_dwordx4 v2, s[12:15], s82 offen lds
    buffer_load_dwordx4 v3, s[12:15], s82 offen offset:1024 lds
    s_add_u32 m0, s89, 34816
    s_add_u32 s82, s69, 14336
    buffer_load_dwordx4 v2, s[12:15], s82 offen lds
    buffer_load_dwordx4 v3, s[12:15], s82 offen offset:1024 lds
    s_add_u32 m0, s89, 49152
    s_add_u32 s82, s70, 0
    buffer_load_dwordx4 v2, s[12:15], s82 offen lds
    buffer_load_dwordx4 v3, s[12:15], s82 offen offset:1024 lds
    s_add_u32 m0, s89, 51200
    s_add_u32 s82, s70, 14336
    buffer_load_dwordx4 v2, s[12:15], s82 offen lds
    buffer_load_dwordx4 v3, s[12:15], s82 offen offset:1024 lds
    s_mov_b64 exec, 0xffff
    buffer_load_dword v17, v14, s[20:23], s93 offen sc1
    s_mov_b64 exec, -1
    v_mfma_f32_16x16x32_bf16 v[128:131], v[56:59], v[24:27], 0
    v_mfma_f32_16x16x32_bf16 v[128:131], v[72:75], v[40:43], v[128:131]
    v_mfma_f32_16x16x32_bf16 v[136:139], v[56:59], v[28:31], 0
    v_mfma_f32_16x16x32_bf16 v[136:139], v[72:75], v[44:47], v[136:139]
    v_mfma_f32_16x16x32_bf16 v[144:147], v[56:59], v[32:35], 0
    v_mfma_f32_16x16x32_bf16 v[144:147], v[72:75], v[48:51], v[144:147]
    v_mfma_f32_16x16x32_bf16 v[152:155], v[56:59], v[36:39], 0
    v_mfma_f32_16x16x32_bf16 v[152:155], v[72:75], v[52:55], v[152:155]
    v_mfma_f32_16x16x32_bf16 v[132:135], v[60:63], v[24:27], 0
    v_mfma_f32_16x16x32_bf16 v[132:135], v[76:79], v[40:43], v[132:135]
    v_mfma_f32_16x16x32_bf16 v[140:143], v[60:63], v[28:31], 0
    v_mfma_f32_16x16x32_bf16 v[140:143], v[76:79], v[44:47], v[140:143]
    v_mfma_f32_16x16x32_bf16 v[148:151], v[60:63], v[32:35], 0
    v_mfma_f32_16x16x32_bf16 v[148:151], v[76:79], v[48:51], v[148:151]
    v_mfma_f32_16x16x32_bf16 v[156:159], v[60:63], v[36:39], 0
    v_mfma_f32_16x16x32_bf16 v[156:159], v[76:79], v[52:55], v[156:159]
    v_mfma_f32_16x16x32_bf16 v[160:163], v[64:67], v[24:27], 0
    v_mfma_f32_16x16x32_bf16 v[160:163], v[80:83], v[40:43], v[160:163]
    v_mfma_f32_16x16x32_bf16 v[168:171], v[64:67], v[28:31], 0
    v_mfma_f32_16x16x32_bf16 v[168:171], v[80:83], v[44:47], v[168:171]
    v_mfma_f32_16x16x32_bf16 v[176:179], v[64:67], v[32:35], 0
    v_mfma_f32_16x16x32_bf16 v[176:179], v[80:83], v[48:51], v[176:179]
    v_mfma_f32_16x16x32_bf16 v[184:187], v[64:67], v[36:39], 0
    v_mfma_f32_16x16x32_bf16 v[184:187], v[80:83], v[52:55], v[184:187]
    v_mfma_f32_16x16x32_bf16 v[164:167], v[68:71], v[24:27], 0
    v_mfma_f32_16x16x32_bf16 v[164:167], v[84:87], v[40:43], v[164:167]
    v_mfma_f32_16x16x32_bf16 v[172:175], v[68:71], v[28:31], 0
    v_mfma_f32_16x16x32_bf16 v[172:175], v[84:87], v[44:47], v[172:175]
    v_mfma_f32_16x16x32_bf16 v[180:183], v[68:71], v[32:35], 0
    v_mfma_f32_16x16x32_bf16 v[180:183], v[84:87], v[48:51], v[180:183]
    v_mfma_f32_16x16x32_bf16 v[188:191], v[68:71], v[36:39], 0
    v_mfma_f32_16x16x32_bf16 v[188:191], v[84:87], v[52:55], v[188:191]
    s_mov_b64 exec, 0xffff
    s_waitcnt vmcnt(0)
    v_cmp_eq_u32 vcc, s84, v17
    s_nop 1
    s_cmp_eq_u64 vcc, exec
    s_cbranch_scc1 K_hhok
    s_mov_b32 s95, 0
SP_12:
    buffer_load_dword v17, v14, s[20:23], s93 offen sc1
    s_waitcnt vmcnt(0)
    v_cmp_eq_u32 vcc, s84, v17
    s_nop 1
    s_cmp_eq_u64 vcc, exec
    s_cbranch_scc1 SP_12_ok
    s_sleep 1
    s_add_u32 s95, s95, 1
    s_cmp_lt_u32 s95, 2097152
    s_cbranch_scc1 SP_12
SP_12_ok:
K_hhok:
    s_mov_b64 exec, -1
    ds_write_b32 v19, v126 offset:112
    buffer_load_dwordx4 v[192:195], v10, s[20:23], s46 offen offset:0 sc1
    buffer_load_dwordx4 v[196:199], v10, s[20:23], s46 offen offset:1024 sc1
    s_add_u32 s71, s46, 114688
    buffer_load_dwordx4 v[200:203], v10, s[20:23], s71 offen offset:0 sc1
    buffer_load_dwordx4 v[204:207], v10, s[20:23], s71 offen offset:1024 sc1
    buffer_load_dwordx4 v[208:211], v10, s[20:23], s47 offen offset:0 sc1
    buffer_load_dwordx4 v[212:215], v10, s[20:23], s47 offen offset:1024 sc1
    s_add_u32 s71, s47, 114688
    buffer_load_dwordx4 v[216:219], v10, s[20:23], s71 offen offset:0 sc1
    buffer_load_dwordx4 v[220:223], v10, s[20:23], s71 offen offset:1024 sc1
    buffer_load_dwordx4 v[224:227], v10, s[20:23], s48 offen offset:0 sc1
    buffer_load_dwordx4 v[228:231], v10, s[20:23], s48 offen offset:1024 sc1
    s_add_u32 s71, s48, 114688
    buffer_load_dwordx4 v[232:235], v10, s[20:23], s71 offen offset:0 sc1
    buffer_load_dwordx4 v[236:239], v10, s[20:23], s71 offen offset:1024 sc1
    buffer_load_dwordx4 v[240:243], v10, s[20:23], s49 offen offset:0 sc1
    buffer_load_dwordx4 v[244:247], v10, s[20:23], s49 offen offset:1024 sc1
    s_add_u32 s71, s49, 114688
    buffer_load_dwordx4 v[248:251], v10, s[20:23], s71 offen offset:0 sc1
    ds_read_b64_tr_b16 v[24:25], v108 offset:2048
    ds_read_b64_tr_b16 v[26:27], v112 offset:32768
    ds_read_b64_tr_b16 v[28:29], v109 offset:2048
    ds_read_b64_tr_b16 v[30:31], v113 offset:32768
    ds_read_b64_tr_b16 v[32:33], v110 offset:2048
    ds_read_b64_tr_b16 v[34:35], v114 offset:32768
    ds_read_b64_tr_b16 v[36:37], v111 offset:2048
    ds_read_b64_tr_b16 v[38:39], v115 offset:32768
    s_sub_u32 s42, s40, 2752512
    s_waitcnt vmcnt(14) lgkmcnt(4)
    v_mfma_f32_16x16x32_bf16 v[128:131], v[192:195], v[24:27], v[128:131]
    ds_read_b64_tr_b16 v[40:41], v108 offset:6144
    ds_read_b64_tr_b16 v[42:43], v112 offset:34816
    v_mfma_f32_16x16x32_bf16 v[136:139], v[192:195], v[28:31], v[136:139]
    ds_read_b64_tr_b16 v[44:45], v109 offset:6144
    ds_read_b64_tr_b16 v[46:47], v113 offset:34816
    s_waitcnt lgkmcnt(4)
    v_mfma_f32_16x16x32_bf16 v[144:147], v[192:195], v[32:35], v[144:147]
    ds_read_b64_tr_b16 v[48:49], v110 offset:6144
    ds_read_b64_tr_b16 v[50:51], v114 offset:34816
    v_mfma_f32_16x16x32_bf16 v[152:155], v[192:195], v[36:39], v[152:155]
    ds_read_b64_tr_b16 v[52:53], v111 offset:6144
    ds_read_b64_tr_b16 v[54:55], v115 offset:34816
    s_waitcnt vmcnt(13)
    v_mfma_f32_16x16x32_bf16 v[132:135], v[196:199], v[24:27], v[132:135]
    buffer_load_dwordx4 v[252:255], v10, s[20:23], s71 offen offset:1024 sc1
    v_mfma_f32_16x16x32_bf16 v[140:143], v[196:199], v[28:31], v[140:143]
    v_mfma_f32_16x16x32_bf16 v[148:151], v[196:199], v[32:35], v[148:151]
    buffer_load_dwordx4 v[192:195], v10, s[20:23], s50 offen offset:0 sc1
    v_mfma_f32_16x16x32_bf16 v[156:159], v[196:199], v[36:39], v[156:159]
    s_waitcnt vmcnt(14) lgkmcnt(4)
    v_mfma_f32_16x16x32_bf16 v[128:131], v[200:203], v[40:43], v[128:131]
    ds_read_b64_tr_b16 v[24:25], v112 offset:40960
    ds_read_b64_tr_b16 v[26:27], v112 offset:8192
    v_mfma_f32_16x16x32_bf16 v[136:139], v[200:203], v[44:47], v[136:139]
    ds_read_b64_tr_b16 v[28:29], v113 offset:40960
    ds_read_b64_tr_b16 v[30:31], v113 offset:8192
    s_waitcnt lgkmcnt(4)
    v_mfma_f32_16x16x32_bf16 v[144:147], v[200:203], v[48:51], v[144:147]
    ds_read_b64_tr_b16 v[32:33], v114 offset:40960
    ds_read_b64_tr_b16 v[34:35], v114 offset:8192
    v_mfma_f32_16x16x32_bf16 v[152:155], v[200:203], v[52:55], v[152:155]
    ds_read_b64_tr_b16 v[36:37], v115 offset:40960
    ds_read_b64_tr_b16 v[38:39], v115 offset:8192
    s_waitcnt vmcnt(13)
    v_mfma_f32_16x16x32_bf16 v[132:135], v[204:207], v[40:43], v[132:135]
    buffer_load_dwordx4 v[196:199], v10, s[20:23], s50 offen offset:1024 sc1
    v_mfma_f32_16x16x32_bf16 v[140:143], v[204:207], v[44:47], v[140:143]
    v_mfma_f32_16x16x32_bf16 v[148:151], v[204:207], v[48:51], v[148:151]
    s_add_u32 s71, s50, 114688
    buffer_load_dwordx4 v[200:203], v10, s[20:23], s71 offen offset:0 sc1
    v_mfma_f32_16x16x32_bf16 v[156:159], v[204:207], v[52:55], v[156:159]
    s_waitcnt vmcnt(14) lgkmcnt(4)
    v_mfma_f32_16x16x32_bf16 v[128:131], v[208:211], v[24:27], v[128:131]
    ds_read_b64_tr_b16 v[40:41], v112 offset:43008
    ds_read_b64_tr_b16 v[42:43], v112 offset:10240
    v_mfma_f32_16x16x32_bf16 v[136:139], v[208:211], v[28:31], v[136:139]
    ds_read_b64_tr_b16 v[44:45], v113 offset:43008
    ds_read_b64_tr_b16 v[46:47], v113 offset:10240
    s_waitcnt lgkmcnt(4)
    v_mfma_f32_16x16x32_bf16 v[144:147], v[208:211], v[32:35], v[144:147]
    ds_read_b64_tr_b16 v[48:49], v114 offset:43008
    ds_read_b64_tr_b16 v[50:51], v114 offset:10240
    v_mfma_f32_16x16x32_bf16 v[152:155], v[208:211], v[36:39], v[152:155]
    ds_read_b64_tr_b16 v[52:53], v115 offset:43008
    ds_read_b64_tr_b16 v[54:55], v115 offset:10240
    s_waitcnt vmcnt(13)
    v_mfma_f32_16x16x32_bf16 v[132:135], v[212:215], v[24:27], v[132:135]
    buffer_load_dwordx4 v[204:207], v10, s[20:23], s71 offen offset:1024 sc1
    v_mfma_f32_16x16x32_bf16 v[140:143], v[212:215], v[28:31], v[140:143]
    v_mfma_f32_16x16x32_bf16 v[148:151], v[212:215], v[32:35], v[148:151]
    buffer_load_dwordx4 v[208:211], v10, s[20:23], s51 offen offset:0 sc1
    v_mfma_f32_16x16x32_bf16 v[156:159], v[212:215], v[36:39], v[156:159]
    s_waitcnt vmcnt(14) lgkmcnt(4)
    v_mfma_f32_16x16x32_bf16 v[128:131], v[216:219], v[40:43], v[128:131]
    ds_read_b64_tr_b16 v[24:25], v112 offset:16384
    ds_read_b64_tr_b16 v[26:27], v112 offset:24576
    v_mfma_f32_16x16x32_bf16 v[136:139], v[216:219], v[44:47], v[136:139]
    ds_read_b64_tr_b16 v[28:29], v113 offset:16384
    ds_read_b64_tr_b16 v[30:31], v113 offset:24576
    s_waitcnt lgkmcnt(4)
    v_mfma_f32_16x16x32_bf16 v[144:147], v[216:219], v[48:51], v[144:147]
    ds_read_b64_tr_b16 v[32:33], v114 offset:16384
    ds_read_b64_tr_b16 v[34:35], v114 offset:24576
    v_mfma_f32_16x16x32_bf16 v[152:155], v[216:219], v[52:55], v[152:155]
    ds_read_b64_tr_b16 v[36:37], v115 offset:16384
    ds_read_b64_tr_b16 v[38:39], v115 offset:24576
    s_waitcnt vmcnt(13)
    v_mfma_f32_16x16x32_bf16 v[132:135], v[220:223], v[40:43], v[132:135]
    buffer_load_dwordx4 v[212:215], v10, s[20:23], s51 offen offset:1024 sc1
    ds_read_b32 v121, v9 offset:112
    v_mfma_f32_16x16x32_bf16 v[140:143], v[220:223], v[44:47], v[140:143]
    v_mfma_f32_16x16x32_bf16 v[148:151], v[220:223], v[48:51], v[148:151]
    s_add_u32 s71, s51, 114688
    buffer_load_dwordx4 v[216:219], v10, s[20:23], s71 offen offset:0 sc1
    v_mfma_f32_16x16x32_bf16 v[156:159], v[220:223], v[52:55], v[156:159]
    s_waitcnt vmcnt(14) lgkmcnt(5)
    v_mfma_f32_16x16x32_bf16 v[128:131], v[224:227], v[24:27], v[128:131]
    ds_read_b64_tr_b16 v[40:41], v112 offset:18432
    ds_read_b64_tr_b16 v[42:43], v112 offset:26624
    v_mfma_f32_16x16x32_bf16 v[136:139], v[224:227], v[28:31], v[136:139]
    ds_read_b64_tr_b16 v[44:45], v113 offset:18432
    ds_read_b64_tr_b16 v[46:47], v113 offset:26624
    s_waitcnt lgkmcnt(5)
    v_mfma_f32_16x16x32_bf16 v[144:147], v[224:227], v[32:35], v[144:147]
    ds_read_b64_tr_b16 v[48:49], v114 offset:18432
    ds_read_b64_tr_b16 v[50:51], v114 offset:26624
    v_mfma_f32_16x16x32_bf16 v[152:155], v[224:227], v[36:39], v[152:155]
    ds_read_b64_tr_b16 v[52:53], v115 offset:18432
    ds_read_b64_tr_b16 v[54:55], v115 offset:26624
    s_waitcnt vmcnt(13)
    v_mfma_f32_16x16x32_bf16 v[132:135], v[228:231], v[24:27], v[132:135]
    buffer_load_dwordx4 v[220:223], v10, s[20:23], s71 offen offset:1024 sc1
    s_waitcnt lgkmcnt(8)
    v_readfirstlane_b32 s82, v121
    s_cmp_eq_u32 s82, 0
    s_cbranch_scc1 WL_13
WL_13_r:
    v_mfma_f32_16x16x32_bf16 v[140:143], v[228:231], v[28:31], v[140:143]
    v_mfma_f32_16x16x32_bf16 v[148:151], v[228:231], v[32:35], v[148:151]
    v_xor_b32 v10, 0x1000, v10
    buffer_load_dwordx4 v[224:227], v10, s[20:23], s46 offen offset:0 sc1
    v_mfma_f32_16x16x32_bf16 v[156:159], v[228:231], v[36:39], v[156:159]
    s_waitcnt vmcnt(14) lgkmcnt(4)
    v_mfma_f32_16x16x32_bf16 v[128:131], v[232:235], v[40:43], v[128:131]
    ds_read_b64_tr_b16 v[24:25], v108 offset:0
    ds_read_b64_tr_b16 v[26:27], v112 offset:0
    v_mfma_f32_16x16x32_bf16 v[136:139], v[232:235], v[44:47], v[136:139]
    ds_read_b64_tr_b16 v[28:29], v109 offset:0
    ds_read_b64_tr_b16 v[30:31], v113 offset:0
    s_waitcnt lgkmcnt(4)
    v_mfma_f32_16x16x32_bf16 v[144:147], v[232:235], v[48:51], v[144:147]
    ds_read_b64_tr_b16 v[32:33], v110 offset:0
    ds_read_b64_tr_b16 v[34:35], v114 offset:0
    v_mfma_f32_16x16x32_bf16 v[152:155], v[232:235], v[52:55], v[152:155]
    ds_read_b64_tr_b16 v[36:37], v111 offset:0
    ds_read_b64_tr_b16 v[38:39], v115 offset:0
    s_waitcnt vmcnt(13)
    v_mfma_f32_16x16x32_bf16 v[132:135], v[236:239], v[40:43], v[132:135]
    buffer_load_dwordx4 v[228:231], v10, s[20:23], s46 offen offset:1024 sc1
    v_mfma_f32_16x16x32_bf16 v[140:143], v[236:239], v[44:47], v[140:143]
    v_mfma_f32_16x16x32_bf16 v[148:151], v[236:239], v[48:51], v[148:151]
    s_add_u32 s71, s46, 114688
    buffer_load_dwordx4 v[232:235], v10, s[20:23], s71 offen offset:0 sc1
    v_mfma_f32_16x16x32_bf16 v[156:159], v[236:239], v[52:55], v[156:159]
    s_waitcnt vmcnt(14) lgkmcnt(4)
    v_mfma_f32_16x16x32_bf16 v[128:131], v[240:243], v[24:27], v[128:131]
    ds_read_b64_tr_b16 v[40:41], v108 offset:4096
    ds_read_b64_tr_b16 v[42:43], v112 offset:2048
    v_mfma_f32_16x16x32_bf16 v[136:139], v[240:243], v[28:31], v[136:139]
    ds_read_b64_tr_b16 v[44:45], v109 offset:4096
    ds_read_b64_tr_b16 v[46:47], v113 offset:2048
    s_waitcnt lgkmcnt(4)
    v_mfma_f32_16x16x32_bf16 v[144:147], v[240:243], v[32:35], v[144:147]
    ds_read_b64_tr_b16 v[48:49], v110 offset:4096
    ds_read_b64_tr_b16 v[50:51], v114 offset:2048
    v_mfma_f32_16x16x32_bf16 v[152:155], v[240:243], v[36:39], v[152:155]
    ds_read_b64_tr_b16 v[52:53], v111 offset:4096
    ds_read_b64_tr_b16 v[54:55], v115 offset:2048
    s_waitcnt vmcnt(13)
    v_mfma_f32_16x16x32_bf16 v[132:135], v[244:247], v[24:27], v[132:135]
    buffer_load_dwordx4 v[236:239], v10, s[20:23], s71 offen offset:1024 sc1
    v_mfma_f32_16x16x32_bf16 v[140:143], v[244:247], v[28:31], v[140:143]
    v_mfma_f32_16x16x32_bf16 v[148:151], v[244:247], v[32:35], v[148:151]
    buffer_load_dwordx4 v[240:243], v10, s[20:23], s47 offen offset:0 sc1
    v_mfma_f32_16x16x32_bf16 v[156:159], v[244:247], v[36:39], v[156:159]
    s_waitcnt vmcnt(14) lgkmcnt(4)
    v_mfma_f32_16x16x32_bf16 v[128:131], v[248:251], v[40:43], v[128:131]
    ds_read_b64_tr_b16 v[24:25], v108 offset:32768
    ds_read_b64_tr_b16 v[26:27], v108 offset:34816
    v_mfma_f32_16x16x32_bf16 v[136:139], v[248:251], v[44:47], v[136:139]
    ds_read_b64_tr_b16 v[28:29], v109 offset:32768
    ds_read_b64_tr_b16 v[30:31], v109 offset:34816
    s_waitcnt lgkmcnt(4)
    v_mfma_f32_16x16x32_bf16 v[144:147], v[248:251], v[48:51], v[144:147]
    ds_read_b64_tr_b16 v[32:33], v110 offset:32768
    ds_read_b64_tr_b16 v[34:35], v110 offset:34816
    v_mfma_f32_16x16x32_bf16 v[152:155], v[248:251], v[52:55], v[152:155]
    ds_read_b64_tr_b16 v[36:37], v111 offset:32768
    ds_read_b64_tr_b16 v[38:39], v111 offset:34816
    s_waitcnt vmcnt(13)
    v_mfma_f32_16x16x32_bf16 v[132:135], v[252:255], v[40:43], v[132:135]
    buffer_load_dwordx4 v[244:247], v10, s[20:23], s47 offen offset:1024 sc1
    v_mfma_f32_16x16x32_bf16 v[140:143], v[252:255], v[44:47], v[140:143]
    v_mfma_f32_16x16x32_bf16 v[148:151], v[252:255], v[48:51], v[148:151]
    s_add_u32 s71, s47, 114688
    buffer_load_dwordx4 v[248:251], v10, s[20:23], s71 offen offset:0 sc1
    v_mfma_f32_16x16x32_bf16 v[156:159], v[252:255], v[52:55], v[156:159]
    s_waitcnt vmcnt(14) lgkmcnt(4)
    v_mfma_f32_16x16x32_bf16 v[128:131], v[192:195], v[24:27], v[128:131]
    ds_read_b64_tr_b16 v[40:41], v108 offset:36864
    ds_read_b64_tr_b16 v[42:43], v108 offset:38912
    v_mfma_f32_16x16x32_bf16 v[136:139], v[192:195], v[28:31], v[136:139]
    ds_read_b64_tr_b16 v[44:45], v109 offset:36864
    ds_read_b64_tr_b16 v[46:47], v109 offset:38912
    s_waitcnt lgkmcnt(4)
    v_mfma_f32_16x16x32_bf16 v[144:147], v[192:195], v[32:35], v[144:147]
    ds_read_b64_tr_b16 v[48:49], v110 offset:36864
    ds_read_b64_tr_b16 v[50:51], v110 offset:38912
    v_mfma_f32_16x16x32_bf16 v[152:155], v[192:195], v[36:39], v[152:155]
    ds_read_b64_tr_b16 v[52:53], v111 offset:36864
    ds_read_b64_tr_b16 v[54:55], v111 offset:38912
    s_waitcnt vmcnt(13)
    v_mfma_f32_16x16x32_bf16 v[132:135], v[196:199], v[24:27], v[132:135]
    buffer_load_dwordx4 v[252:255], v10, s[20:23], s71 offen offset:1024 sc1
    v_mfma_f32_16x16x32_bf16 v[140:143], v[196:199], v[28:31], v[140:143]
    v_mfma_f32_16x16x32_bf16 v[148:151], v[196:199], v[32:35], v[148:151]
    buffer_load_dwordx4 v[192:195], v10, s[20:23], s48 offen offset:0 sc1
    v_mfma_f32_16x16x32_bf16 v[156:159], v[196:199], v[36:39], v[156:159]
    s_waitcnt vmcnt(14) lgkmcnt(4)
    v_mfma_f32_16x16x32_bf16 v[128:131], v[200:203], v[40:43], v[128:131]
    ds_read_b64_tr_b16 v[24:25], v108 offset:49152
    ds_read_b64_tr_b16 v[26:27], v108 offset:51200
    v_mfma_f32_16x16x32_bf16 v[136:139], v[200:203], v[44:47], v[136:139]
    ds_read_b64_tr_b16 v[28:29], v109 offset:49152
    ds_read_b64_tr_b16 v[30:31], v109 offset:51200
    s_waitcnt lgkmcnt(4)
    v_mfma_f32_16x16x32_bf16 v[144:147], v[200:203], v[48:51], v[144:147]
    ds_read_b64_tr_b16 v[32:33], v110 offset:49152
    ds_read_b64_tr_b16 v[34:35], v110 offset:51200
    v_mfma_f32_16x16x32_bf16 v[152:155], v[200:203], v[52:55], v[152:155]
    ds_read_b64_tr_b16 v[36:37], v111 offset:49152
    ds_read_b64_tr_b16 v[38:39], v111 offset:51200
    s_waitcnt vmcnt(13)
    v_mfma_f32_16x16x32_bf16 v[132:135], v[204:207], v[40:43], v[132:135]
    buffer_load_dwordx4 v[196:199], v10, s[20:23], s48 offen offset:1024 sc1
    v_mfma_f32_16x16x32_bf16 v[140:143], v[204:207], v[44:47], v[140:143]
    v_mfma_f32_16x16x32_bf16 v[148:151], v[204:207], v[48:51], v[148:151]
    s_add_u32 s71, s48, 114688
    buffer_load_dwordx4 v[200:203], v10, s[20:23], s71 offen offset:0 sc1
    v_mfma_f32_16x16x32_bf16 v[156:159], v[204:207], v[52:55], v[156:159]
    s_waitcnt vmcnt(14) lgkmcnt(4)
    v_mfma_f32_16x16x32_bf16 v[128:131], v[208:211], v[24:27], v[128:131]
    ds_read_b64_tr_b16 v[40:41], v108 offset:53248
    ds_read_b64_tr_b16 v[42:43], v108 offset:55296
    v_mfma_f32_16x16x32_bf16 v[136:139], v[208:211], v[28:31], v[136:139]
    ds_read_b64_tr_b16 v[44:45], v109 offset:53248
    ds_read_b64_tr_b16 v[46:47], v109 offset:55296
    s_waitcnt lgkmcnt(4)
    v_mfma_f32_16x16x32_bf16 v[144:147], v[208:211], v[32:35], v[144:147]
    ds_read_b64_tr_b16 v[48:49], v110 offset:53248
    ds_read_b64_tr_b16 v[50:51], v110 offset:55296
    v_mfma_f32_16x16x32_bf16 v[152:155], v[208:211], v[36:39], v[152:155]
    ds_read_b64_tr_b16 v[52:53], v111 offset:53248
    ds_read_b64_tr_b16 v[54:55], v111 offset:55296
    s_waitcnt vmcnt(13)
    v_mfma_f32_16x16x32_bf16 v[132:135], v[212:215], v[24:27], v[132:135]
    buffer_load_dwordx4 v[204:207], v10, s[20:23], s71 offen offset:1024 sc1
    ds_read_b32 v121, v8 offset:84
    v_mfma_f32_16x16x32_bf16 v[140:143], v[212:215], v[28:31], v[140:143]
    v_mfma_f32_16x16x32_bf16 v[148:151], v[212:215], v[32:35], v[148:151]
    buffer_load_dwordx4 v[208:211], v10, s[20:23], s49 offen offset:0 sc1
    v_mfma_f32_16x16x32_bf16 v[156:159], v[212:215], v[36:39], v[156:159]
    s_waitcnt vmcnt(14) lgkmcnt(5)
    v_mfma_f32_16x16x32_bf16 v[128:131], v[216:219], v[40:43], v[128:131]
    ds_read_b64_tr_b16 v[24:25], v108 offset:2048
    ds_read_b64_tr_b16 v[26:27], v112 offset:32768
    v_mfma_f32_16x16x32_bf16 v[136:139], v[216:219], v[44:47], v[136:139]
    ds_read_b64_tr_b16 v[28:29], v109 offset:2048
    ds_read_b64_tr_b16 v[30:31], v113 offset:32768
    s_waitcnt lgkmcnt(5)
    v_mfma_f32_16x16x32_bf16 v[144:147], v[216:219], v[48:51], v[144:147]
    ds_read_b64_tr_b16 v[32:33], v110 offset:2048
    ds_read_b64_tr_b16 v[34:35], v114 offset:32768
    v_mfma_f32_16x16x32_bf16 v[152:155], v[216:219], v[52:55], v[152:155]
    ds_read_b64_tr_b16 v[36:37], v111 offset:2048
    ds_read_b64_tr_b16 v[38:39], v115 offset:32768
    s_waitcnt vmcnt(13)
    v_mfma_f32_16x16x32_bf16 v[132:135], v[220:223], v[40:43], v[132:135]
    buffer_load_dwordx4 v[212:215], v10, s[20:23], s49 offen offset:1024 sc1
    s_waitcnt lgkmcnt(8)
    v_readfirstlane_b32 s82, v121
    s_cmp_lt_u32 s82, 4
    s_cbranch_scc1 YX_14
YX_14_r:
    v_mfma_f32_16x16x32_bf16 v[140:143], v[220:223], v[44:47], v[140:143]
    v_mfma_f32_16x16x32_bf16 v[148:151], v[220:223], v[48:51], v[148:151]
    s_add_u32 s71, s49, 114688
    buffer_load_dwordx4 v[216:219], v10, s[20:23], s71 offen offset:0 sc1
    v_mfma_f32_16x16x32_bf16 v[156:159], v[220:223], v[52:55], v[156:159]
    s_waitcnt vmcnt(14) lgkmcnt(4)
    v_mfma_f32_16x16x32_bf16 v[160:163], v[224:227], v[24:27], v[160:163]
    ds_read_b64_tr_b16 v[40:41], v108 offset:6144
    ds_read_b64_tr_b16 v[42:43], v112 offset:34816
    v_mfma_f32_16x16x32_bf16 v[168:171], v[224:227], v[28:31], v[168:171]
    ds_read_b64_tr_b16 v[44:45], v109 offset:6144
    ds_read_b64_tr_b16 v[46:47], v113 offset:34816
    s_waitcnt lgkmcnt(4)
    v_mfma_f32_16x16x32_bf16 v[176:179], v[224:227], v[32:35], v[176:179]
    ds_read_b64_tr_b16 v[48:49], v110 offset:6144
    ds_read_b64_tr_b16 v[50:51], v114 offset:34816
    v_mfma_f32_16x16x32_bf16 v[184:187], v[224:227], v[36:39], v[184:187]
    ds_read_b64_tr_b16 v[52:53], v111 offset:6144
    ds_read_b64_tr_b16 v[54:55], v115 offset:34816
    s_waitcnt vmcnt(13)
    v_mfma_f32_16x16x32_bf16 v[164:167], v[228:231], v[24:27], v[164:167]
    buffer_load_dwordx4 v[220:223], v10, s[20:23], s71 offen offset:1024 sc1
    ds_write_b128 v4, v[144:147] offset:16384
    ds_write_b128 v4, v[148:151] offset:17408
    v_mfma_f32_16x16x32_bf16 v[172:175], v[228:231], v[28:31], v[172:175]
    ds_write_b128 v4, v[152:155] offset:18432
    ds_write_b128 v4, v[156:159] offset:19456
    ds_write_b32 v19, v126 offset:48
    v_mfma_f32_16x16x32_bf16 v[180:183], v[228:231], v[32:35], v[180:183]
    buffer_load_dwordx4 v[224:227], v10, s[20:23], s50 offen offset:0 sc1
    v_mfma_f32_16x16x32_bf16 v[188:191], v[228:231], v[36:39], v[188:191]
    s_waitcnt vmcnt(14) lgkmcnt(9)
    v_mfma_f32_16x16x32_bf16 v[160:163], v[232:235], v[40:43], v[160:163]
    ds_read_b64_tr_b16 v[24:25], v112 offset:40960
    ds_read_b64_tr_b16 v[26:27], v112 offset:8192
    v_mfma_f32_16x16x32_bf16 v[168:171], v[232:235], v[44:47], v[168:171]
    ds_read_b64_tr_b16 v[28:29], v113 offset:40960
    ds_read_b64_tr_b16 v[30:31], v113 offset:8192
    s_waitcnt lgkmcnt(9)
    v_mfma_f32_16x16x32_bf16 v[176:179], v[232:235], v[48:51], v[176:179]
    ds_read_b64_tr_b16 v[32:33], v114 offset:40960
    ds_read_b64_tr_b16 v[34:35], v114 offset:8192
    v_mfma_f32_16x16x32_bf16 v[184:187], v[232:235], v[52:55], v[184:187]
    ds_read_b64_tr_b16 v[36:37], v115 offset:40960
    ds_read_b64_tr_b16 v[38:39], v115 offset:8192
    s_waitcnt vmcnt(13)
    v_mfma_f32_16x16x32_bf16 v[164:167], v[236:239], v[40:43], v[164:167]
    buffer_load_dwordx4 v[228:231], v10, s[20:23], s50 offen offset:1024 sc1
    ds_read_b32 v121, v6 offset:48
    ds_read_b128 v[144:147], v5 offset:16384
    ds_read_b128 v[148:151], v5 offset:17408
    ds_read_b128 v[152:155], v5 offset:18432
    ds_read_b128 v[156:159], v5 offset:19456
    v_mfma_f32_16x16x32_bf16 v[172:175], v[236:239], v[44:47], v[172:175]
    v_mfma_f32_16x16x32_bf16 v[180:183], v[236:239], v[48:51], v[180:183]
    s_add_u32 s71, s50, 114688
    buffer_load_dwordx4 v[232:235], v10, s[20:23], s71 offen offset:0 sc1
    v_mfma_f32_16x16x32_bf16 v[188:191], v[236:239], v[52:55], v[188:191]
    s_waitcnt lgkmcnt(0)
    v_readfirstlane_b32 s82, v121
    s_cmp_eq_u32 s82, 0
    s_cbranch_scc1 PX_15
PX_15_r:
    ds_write_b32 v19, v126 offset:64
    s_waitcnt vmcnt(14)
    v_mfma_f32_16x16x32_bf16 v[160:163], v[240:243], v[24:27], v[160:163]
    ds_read_b64_tr_b16 v[40:41], v112 offset:43008
    ds_read_b64_tr_b16 v[42:43], v112 offset:10240
    v_mfma_f32_16x16x32_bf16 v[168:171], v[240:243], v[28:31], v[168:171]
    ds_read_b64_tr_b16 v[44:45], v113 offset:43008
    ds_read_b64_tr_b16 v[46:47], v113 offset:10240
    v_mfma_f32_16x16x32_bf16 v[176:179], v[240:243], v[32:35], v[176:179]
    ds_read_b64_tr_b16 v[48:49], v114 offset:43008
    ds_read_b64_tr_b16 v[50:51], v114 offset:10240
    v_mfma_f32_16x16x32_bf16 v[184:187], v[240:243], v[36:39], v[184:187]
    ds_read_b64_tr_b16 v[52:53], v115 offset:43008
    ds_read_b64_tr_b16 v[54:55], v115 offset:10240
    s_waitcnt vmcnt(13)
    v_mfma_f32_16x16x32_bf16 v[164:167], v[244:247], v[24:27], v[164:167]
    buffer_load_dwordx4 v[236:239], v10, s[20:23], s71 offen offset:1024 sc1
    v_add_f32 v128, v128, v144
    v_add_f32 v129, v129, v145
    v_add_f32 v130, v130, v146
    v_add_f32 v131, v131, v147
    v_mfma_f32_16x16x32_bf16 v[172:175], v[244:247], v[28:31], v[172:175]
    v_add_f32 v132, v132, v148
    v_add_f32 v133, v133, v149
    v_add_f32 v134, v134, v150
    v_add_f32 v135, v135, v151
    v_mfma_f32_16x16x32_bf16 v[180:183], v[244:247], v[32:35], v[180:183]
    buffer_load_dwordx4 v[240:243], v10, s[20:23], s51 offen offset:0 sc1
    v_cvt_pk_bf16_f32 v56, v128, v129
    v_cvt_pk_bf16_f32 v57, v130, v131
    v_cvt_pk_bf16_f32 v58, v132, v133
    v_mov_b32 v59, s84
    buffer_store_dwordx4 v[56:59], v18, s[20:23], s41 offen offset:0 sc1
    v_mfma_f32_16x16x32_bf16 v[188:191], v[244:247], v[36:39], v[188:191]
    v_add_f32 v136, v136, v152
    v_add_f32 v137, v137, v153
    v_add_f32 v138, v138, v154
    v_add_f32 v139, v139, v155
    s_waitcnt vmcnt(15) lgkmcnt(4)
    v_mfma_f32_16x16x32_bf16 v[160:163], v[248:251], v[40:43], v[160:163]
    ds_read_b64_tr_b16 v[24:25], v112 offset:16384
    ds_read_b64_tr_b16 v[26:27], v112 offset:24576
    v_mfma_f32_16x16x32_bf16 v[168:171], v[248:251], v[44:47], v[168:171]
    ds_read_b64_tr_b16 v[28:29], v113 offset:16384
    ds_read_b64_tr_b16 v[30:31], v113 offset:24576
    s_waitcnt lgkmcnt(4)
    v_mfma_f32_16x16x32_bf16 v[176:179], v[248:251], v[48:51], v[176:179]
    ds_read_b64_tr_b16 v[32:33], v114 offset:16384
    ds_read_b64_tr_b16 v[34:35], v114 offset:24576
    v_mfma_f32_16x16x32_bf16 v[184:187], v[248:251], v[52:55], v[184:187]
    ds_read_b64_tr_b16 v[36:37], v115 offset:16384
    ds_read_b64_tr_b16 v[38:39], v115 offset:24576
    s_waitcnt vmcnt(14)
    v_mfma_f32_16x16x32_bf16 v[164:167], v[252:255], v[40:43], v[164:167]
    buffer_load_dwordx4 v[244:247], v10, s[20:23], s51 offen offset:1024 sc1
    v_cvt_pk_bf16_f32 v60, v134, v135
    v_cvt_pk_bf16_f32 v61, v136, v137
    v_cvt_pk_bf16_f32 v62, v138, v139
    v_mov_b32 v63, s84
    buffer_store_dwordx4 v[60:63], v18, s[20:23], s41 offen offset:1024 sc1
    v_mfma_f32_16x16x32_bf16 v[172:175], v[252:255], v[44:47], v[172:175]
    v_add_f32 v140, v140, v156
    v_add_f32 v141, v141, v157
    v_add_f32 v142, v142, v158
    v_add_f32 v143, v143, v159
    v_mfma_f32_16x16x32_bf16 v[180:183], v[252:255], v[48:51], v[180:183]
    s_add_u32 s71, s51, 114688
    buffer_load_dwordx4 v[248:251], v10, s[20:23], s71 offen offset:0 sc1
    v_cvt_pk_bf16_f32 v64, v140, v141
    v_cvt_pk_bf16_f32 v65, v142, v143
    v_mov_b32 v66, s84
    v_mov_b32 v67, s84
    buffer_store_dwordx4 v[64:67], v18, s[20:23], s41 offen offset:2048 sc1
    v_mfma_f32_16x16x32_bf16 v[188:191], v[252:255], v[52:55], v[188:191]
    s_waitcnt vmcnt(17) lgkmcnt(4)
    v_mfma_f32_16x16x32_bf16 v[160:163], v[192:195], v[24:27], v[160:163]
    ds_read_b64_tr_b16 v[40:41], v112 offset:18432
    ds_read_b64_tr_b16 v[42:43], v112 offset:26624
    v_mfma_f32_16x16x32_bf16 v[168:171], v[192:195], v[28:31], v[168:171]
    ds_read_b64_tr_b16 v[44:45], v113 offset:18432
    ds_read_b64_tr_b16 v[46:47], v113 offset:26624
    s_waitcnt lgkmcnt(4)
    v_mfma_f32_16x16x32_bf16 v[176:179], v[192:195], v[32:35], v[176:179]
    ds_read_b64_tr_b16 v[48:49], v114 offset:18432
    ds_read_b64_tr_b16 v[50:51], v114 offset:26624
    v_mfma_f32_16x16x32_bf16 v[184:187], v[192:195], v[36:39], v[184:187]
    ds_read_b64_tr_b16 v[52:53], v115 offset:18432
    ds_read_b64_tr_b16 v[54:55], v115 offset:26624
    s_waitcnt vmcnt(16)
    v_mfma_f32_16x16x32_bf16 v[164:167], v[196:199], v[24:27], v[164:167]
    buffer_load_dwordx4 v[252:255], v10, s[20:23], s71 offen offset:1024 sc1
    v_mfma_f32_16x16x32_bf16 v[172:175], v[196:199], v[28:31], v[172:175]
    v_mfma_f32_16x16x32_bf16 v[180:183], v[196:199], v[32:35], v[180:183]
    v_mfma_f32_16x16x32_bf16 v[188:191], v[196:199], v[36:39], v[188:191]
    s_waitcnt vmcnt(16) lgkmcnt(4)
    v_mfma_f32_16x16x32_bf16 v[160:163], v[200:203], v[40:43], v[160:163]
    ds_read_b64_tr_b16 v[24:25], v108 offset:0
    ds_read_b64_tr_b16 v[26:27], v112 offset:0
    v_mfma_f32_16x16x32_bf16 v[168:171], v[200:203], v[44:47], v[168:171]
    ds_read_b64_tr_b16 v[28:29], v109 offset:0
    ds_read_b64_tr_b16 v[30:31], v113 offset:0
    s_waitcnt lgkmcnt(4)
    v_mfma_f32_16x16x32_bf16 v[176:179], v[200:203], v[48:51], v[176:179]
    ds_read_b64_tr_b16 v[32:33], v110 offset:0
    ds_read_b64_tr_b16 v[34:35], v114 offset:0
    v_mfma_f32_16x16x32_bf16 v[184:187], v[200:203], v[52:55], v[184:187]
    ds_read_b64_tr_b16 v[36:37], v111 offset:0
    ds_read_b64_tr_b16 v[38:39], v115 offset:0
    s_waitcnt vmcnt(15)
    v_mfma_f32_16x16x32_bf16 v[164:167], v[204:207], v[40:43], v[164:167]
    ds_read_b32 v121, v19 offset:128
    v_mfma_f32_16x16x32_bf16 v[172:175], v[204:207], v[44:47], v[172:175]
    s_waitcnt lgkmcnt(0)
    v_readfirstlane_b32 s82, v121
    s_cmp_eq_u32 s82, 0
    s_cbranch_scc1 YD_16
YD_16_r:
    v_mfma_f32_16x16x32_bf16 v[180:183], v[204:207], v[48:51], v[180:183]
    ds_read_b128 v[72:75], v4 offset:0
    ds_read_b128 v[76:79], v4 offset:1024
    ds_read_b128 v[80:83], v4 offset:2048
    ds_read_b128 v[84:87], v4 offset:3072
    v_mfma_f32_16x16x32_bf16 v[188:191], v[204:207], v[52:55], v[188:191]
    ds_read_b128 v[104:107], v7 offset:0
    ds_read_b128 v[12:15], v7 offset:1024
    s_waitcnt vmcnt(14)
    v_mfma_f32_16x16x32_bf16 v[160:163], v[208:211], v[24:27], v[160:163]
    ds_read_b64_tr_b16 v[40:41], v108 offset:4096
    ds_read_b64_tr_b16 v[42:43], v112 offset:2048
    v_mfma_f32_16x16x32_bf16 v[168:171], v[208:211], v[28:31], v[168:171]
    ds_read_b64_tr_b16 v[44:45], v109 offset:4096
    ds_read_b64_tr_b16 v[46:47], v113 offset:2048
    v_mfma_f32_16x16x32_bf16 v[176:179], v[208:211], v[32:35], v[176:179]
    ds_read_b64_tr_b16 v[48:49], v110 offset:4096
    ds_read_b64_tr_b16 v[50:51], v114 offset:2048
    v_mfma_f32_16x16x32_bf16 v[184:187], v[208:211], v[36:39], v[184:187]
    ds_read_b64_tr_b16 v[52:53], v111 offset:4096
    ds_read_b64_tr_b16 v[54:55], v115 offset:2048
    s_waitcnt vmcnt(13)
    v_mfma_f32_16x16x32_bf16 v[164:167], v[212:215], v[24:27], v[164:167]
    ds_read_b32 v121, v6 offset:64
    v_mfma_f32_16x16x32_bf16 v[172:175], v[212:215], v[28:31], v[172:175]
    v_mfma_f32_16x16x32_bf16 v[180:183], v[212:215], v[32:35], v[180:183]
    s_waitcnt lgkmcnt(0)
    v_lshlrev_b32 v56, 16, v104
    v_and_b32 v57, 0xffff0000, v104
    v_lshlrev_b32 v58, 16, v105
    v_and_b32 v59, 0xffff0000, v105
    v_mfma_f32_16x16x32_bf16 v[188:191], v[212:215], v[36:39], v[188:191]
    v_lshlrev_b32 v60, 16, v106
    v_and_b32 v61, 0xffff0000, v106
    v_lshlrev_b32 v62, 16, v107
    v_and_b32 v63, 0xffff0000, v107
    s_waitcnt vmcnt(12)
    v_mfma_f32_16x16x32_bf16 v[160:163], v[216:219], v[40:43], v[160:163]
    ds_read_b64_tr_b16 v[24:25], v108 offset:32768
    ds_read_b64_tr_b16 v[26:27], v108 offset:34816
    v_mfma_f32_16x16x32_bf16 v[168:171], v[216:219], v[44:47], v[168:171]
    ds_read_b64_tr_b16 v[28:29], v109 offset:32768
    ds_read_b64_tr_b16 v[30:31], v109 offset:34816
    v_mfma_f32_16x16x32_bf16 v[176:179], v[216:219], v[48:51], v[176:179]
    ds_read_b64_tr_b16 v[32:33], v110 offset:32768
    ds_read_b64_tr_b16 v[34:35], v110 offset:34816
    v_mfma_f32_16x16x32_bf16 v[184:187], v[216:219], v[52:55], v[184:187]
    ds_read_b64_tr_b16 v[36:37], v111 offset:32768
    ds_read_b64_tr_b16 v[38:39], v111 offset:34816
    s_waitcnt vmcnt(11)
    v_mfma_f32_16x16x32_bf16 v[164:167], v[220:223], v[40:43], v[164:167]
    v_lshlrev_b32 v64, 16, v12
    v_and_b32 v65, 0xffff0000, v12
    v_lshlrev_b32 v66, 16, v13
    v_and_b32 v67, 0xffff0000, v13
    v_mfma_f32_16x16x32_bf16 v[172:175], v[220:223], v[44:47], v[172:175]
    v_lshlrev_b32 v68, 16, v14
    v_and_b32 v69, 0xffff0000, v14
    v_lshlrev_b32 v70, 16, v15
    v_and_b32 v71, 0xffff0000, v15
    v_mfma_f32_16x16x32_bf16 v[180:183], v[220:223], v[48:51], v[180:183]
    buffer_load_dwordx4 v[128:131], v18, s[20:23], s42 offen offset:0 sc1
    buffer_load_dwordx4 v[132:135], v18, s[20:23], s42 offen offset:1024 sc1
    buffer_load_dwordx4 v[136:139], v18, s[20:23], s42 offen offset:2048 sc1
    v_mfma_f32_16x16x32_bf16 v[188:191], v[220:223], v[52:55], v[188:191]
    s_waitcnt vmcnt(13) lgkmcnt(4)
    v_mfma_f32_16x16x32_bf16 v[160:163], v[224:227], v[24:27], v[160:163]
    ds_read_b64_tr_b16 v[40:41], v108 offset:36864
    ds_read_b64_tr_b16 v[42:43], v108 offset:38912
    v_mfma_f32_16x16x32_bf16 v[168:171], v[224:227], v[28:31], v[168:171]
    ds_read_b64_tr_b16 v[44:45], v109 offset:36864
    ds_read_b64_tr_b16 v[46:47], v109 offset:38912
    s_waitcnt lgkmcnt(4)
    v_mfma_f32_16x16x32_bf16 v[176:179], v[224:227], v[32:35], v[176:179]
    ds_read_b64_tr_b16 v[48:49], v110 offset:36864
    ds_read_b64_tr_b16 v[50:51], v110 offset:38912
    v_mfma_f32_16x16x32_bf16 v[184:187], v[224:227], v[36:39], v[184:187]
    ds_read_b64_tr_b16 v[52:53], v111 offset:36864
    ds_read_b64_tr_b16 v[54:55], v111 offset:38912
    s_waitcnt vmcnt(12)
    v_mfma_f32_16x16x32_bf16 v[164:167], v[228:231], v[24:27], v[164:167]
    v_mfma_f32_16x16x32_bf16 v[172:175], v[228:231], v[28:31], v[172:175]
    v_mfma_f32_16x16x32_bf16 v[180:183], v[228:231], v[32:35], v[180:183]
    v_mfma_f32_16x16x32_bf16 v[188:191], v[228:231], v[36:39], v[188:191]
    s_waitcnt vmcnt(11) lgkmcnt(4)
    v_mfma_f32_16x16x32_bf16 v[160:163], v[232:235], v[40:43], v[160:163]
    ds_read_b64_tr_b16 v[24:25], v108 offset:49152
    ds_read_b64_tr_b16 v[26:27], v108 offset:51200
    v_mfma_f32_16x16x32_bf16 v[168:171], v[232:235], v[44:47], v[168:171]
    ds_read_b64_tr_b16 v[28:29], v109 offset:49152
    ds_read_b64_tr_b16 v[30:31], v109 offset:51200
    s_waitcnt lgkmcnt(4)
    v_mfma_f32_16x16x32_bf16 v[176:179], v[232:235], v[48:51], v[176:179]
    ds_read_b64_tr_b16 v[32:33], v110 offset:49152
    ds_read_b64_tr_b16 v[34:35], v110 offset:51200
    v_mfma_f32_16x16x32_bf16 v[184:187], v[232:235], v[52:55], v[184:187]
    ds_read_b64_tr_b16 v[36:37], v111 offset:49152
    ds_read_b64_tr_b16 v[38:39], v111 offset:51200
    s_waitcnt vmcnt(10)
    v_mfma_f32_16x16x32_bf16 v[164:167], v[236:239], v[40:43], v[164:167]
    v_mfma_f32_16x16x32_bf16 v[172:175], v[236:239], v[44:47], v[172:175]
    v_mfma_f32_16x16x32_bf16 v[180:183], v[236:239], v[48:51], v[180:183]
    v_mfma_f32_16x16x32_bf16 v[188:191], v[236:239], v[52:55], v[188:191]
    s_waitcnt vmcnt(9) lgkmcnt(4)
    v_mfma_f32_16x16x32_bf16 v[160:163], v[240:243], v[24:27], v[160:163]
    ds_read_b64_tr_b16 v[40:41], v108 offset:53248
    ds_read_b64_tr_b16 v[42:43], v108 offset:55296
    v_mfma_f32_16x16x32_bf16 v[168:171], v[240:243], v[28:31], v[168:171]
    ds_read_b64_tr_b16 v[44:45], v109 offset:53248
    ds_read_b64_tr_b16 v[46:47], v109 offset:55296
    s_waitcnt lgkmcnt(4)
    v_mfma_f32_16x16x32_bf16 v[176:179], v[240:243], v[32:35], v[176:179]
    ds_read_b64_tr_b16 v[48:49], v110 offset:53248
    ds_read_b64_tr_b16 v[50:51], v110 offset:55296
    v_mfma_f32_16x16x32_bf16 v[184:187], v[240:243], v[36:39], v[184:187]
    ds_read_b64_tr_b16 v[52:53], v111 offset:53248
    ds_read_b64_tr_b16 v[54:55], v111 offset:55296
    s_waitcnt vmcnt(7)
    v_mfma_f32_16x16x32_bf16 v[164:167], v[244:247], v[24:27], v[164:167]
    v_mfma_f32_16x16x32_bf16 v[172:175], v[244:247], v[28:31], v[172:175]
    v_mfma_f32_16x16x32_bf16 v[180:183], v[244:247], v[32:35], v[180:183]
    v_mfma_f32_16x16x32_bf16 v[188:191], v[244:247], v[36:39], v[188:191]
    s_waitcnt vmcnt(5) lgkmcnt(4)
    v_mfma_f32_16x16x32_bf16 v[160:163], v[248:251], v[40:43], v[160:163]
    v_mfma_f32_16x16x32_bf16 v[168:171], v[248:251], v[44:47], v[168:171]
    s_waitcnt lgkmcnt(0)
    v_mfma_f32_16x16x32_bf16 v[176:179], v[248:251], v[48:51], v[176:179]
    v_mfma_f32_16x16x32_bf16 v[184:187], v[248:251], v[52:55], v[184:187]
    s_waitcnt vmcnt(3)
    v_mfma_f32_16x16x32_bf16 v[164:167], v[252:255], v[40:43], v[164:167]
    buffer_load_dwordx4 v[192:195], v18, s[20:23], s40 offen offset:0 sc1
    buffer_load_dwordx4 v[196:199], v18, s[20:23], s40 offen offset:1024 sc1
    buffer_load_dwordx4 v[200:203], v18, s[20:23], s40 offen offset:2048 sc1
    v_mfma_f32_16x16x32_bf16 v[172:175], v[252:255], v[44:47], v[172:175]
    v_mfma_f32_16x16x32_bf16 v[180:183], v[252:255], v[48:51], v[180:183]
    v_mfma_f32_16x16x32_bf16 v[188:191], v[252:255], v[52:55], v[188:191]
    s_waitcnt lgkmcnt(0)
    v_readfirstlane_b32 s82, v121
    s_cmp_eq_u32 s82, 0
    s_cbranch_scc1 RX_17
RX_17_r:
    s_mov_b32 s28, 0xbfb8aa3b
    s_mov_b32 s29, 0xbfb8aa3b
    s_nop 5
    ds_write_b128 v4, v[176:179] offset:16384
    ds_write_b128 v4, v[180:183] offset:17408
    ds_write_b128 v4, v[184:187] offset:18432
    ds_write_b128 v4, v[188:191] offset:19456
    s_waitcnt vmcnt(3)
    v_min3_u32 v1, s84, v131, v135
    v_max3_u32 v2, s84, v131, v135
    v_min_u32 v1, v1, v139
    v_max_u32 v2, v2, v139
    v_cmp_eq_u32 vcc, v1, v2
    s_nop 1
    s_cmp_eq_u64 vcc, -1
    s_cbranch_scc1 RV_18
    s_mov_b32 s95, 0
SP_19:
    buffer_load_dwordx4 v[128:131], v18, s[20:23], s42 offen offset:0 sc1
    buffer_load_dwordx4 v[132:135], v18, s[20:23], s42 offen offset:1024 sc1
    buffer_load_dwordx4 v[136:139], v18, s[20:23], s42 offen offset:2048 sc1
    s_waitcnt vmcnt(0)
    v_min3_u32 v1, s84, v131, v135
    v_max3_u32 v2, s84, v131, v135
    v_min_u32 v1, v1, v139
    v_max_u32 v2, v2, v139
    v_cmp_eq_u32 vcc, v1, v2
    s_nop 1
    s_cmp_eq_u64 vcc, -1
    s_cbranch_scc1 SP_19_ok
    s_sleep 1
    s_add_u32 s95, s95, 1
    s_cmp_lt_u32 s95, 2097152
    s_cbranch_scc1 SP_19
SP_19_ok:
RV_18:
    v_lshlrev_b32 v144, 16, v128
    v_and_b32 v145, 0xffff0000, v128
    v_lshlrev_b32 v146, 16, v129
    v_and_b32 v147, 0xffff0000, v129
    v_lshlrev_b32 v148, 16, v130
    v_and_b32 v149, 0xffff0000, v130
    v_lshlrev_b32 v150, 16, v132
    v_and_b32 v151, 0xffff0000, v132
    v_lshlrev_b32 v152, 16, v133
    v_and_b32 v153, 0xffff0000, v133
    v_lshlrev_b32 v154, 16, v134
    v_and_b32 v155, 0xffff0000, v134
    v_lshlrev_b32 v156, 16, v136
    v_and_b32 v157, 0xffff0000, v136
    v_lshlrev_b32 v158, 16, v137
    v_and_b32 v159, 0xffff0000, v137
    v_pk_add_f32 v[72:73], v[72:73], v[144:145]
    v_pk_add_f32 v[74:75], v[74:75], v[146:147]
    v_pk_add_f32 v[76:77], v[76:77], v[148:149]
    v_pk_add_f32 v[78:79], v[78:79], v[150:151]
    v_pk_add_f32 v[80:81], v[80:81], v[152:153]
    v_pk_add_f32 v[82:83], v[82:83], v[154:155]
    v_pk_add_f32 v[84:85], v[84:85], v[156:157]
    v_pk_add_f32 v[86:87], v[86:87], v[158:159]
    s_waitcnt lgkmcnt(0)
    s_barrier
    ds_read_b128 v[24:27], v5 offset:16384
    ds_read_b128 v[28:31], v5 offset:17408
    ds_read_b128 v[32:35], v5 offset:18432
    ds_read_b128 v[36:39], v5 offset:19456
    s_waitcnt vmcnt(0)
    v_min3_u32 v1, s84, v195, v199
    v_max3_u32 v2, s84, v195, v199
    v_min_u32 v1, v1, v203
    v_max_u32 v2, v2, v203
    v_cmp_eq_u32 vcc, v1, v2
    s_nop 1
    s_cmp_eq_u64 vcc, -1
    s_cbranch_scc1 RV_20
    s_mov_b32 s95, 0
SP_21:
    buffer_load_dwordx4 v[192:195], v18, s[20:23], s40 offen offset:0 sc1
    buffer_load_dwordx4 v[196:199], v18, s[20:23], s40 offen offset:1024 sc1
    buffer_load_dwordx4 v[200:203], v18, s[20:23], s40 offen offset:2048 sc1
    s_waitcnt vmcnt(0)
    v_min3_u32 v1, s84, v195, v199
    v_max3_u32 v2, s84, v195, v199
    v_min_u32 v1, v1, v203
    v_max_u32 v2, v2, v203
    v_cmp_eq_u32 vcc, v1, v2
    s_nop 1
    s_cmp_eq_u64 vcc, -1
    s_cbranch_scc1 SP_21_ok
    s_sleep 1
    s_add_u32 s95, s95, 1
    s_cmp_lt_u32 s95, 2097152
    s_cbranch_scc1 SP_21
SP_21_ok:
RV_20:
    v_lshlrev_b32 v208, 16, v192
    v_and_b32 v209, 0xffff0000, v192
    v_lshlrev_b32 v210, 16, v193
    v_and_b32 v211, 0xffff0000, v193
    v_lshlrev_b32 v212, 16, v194
    v_and_b32 v213, 0xffff0000, v194
    v_lshlrev_b32 v214, 16, v196
    v_and_b32 v215, 0xffff0000, v196
    v_lshlrev_b32 v216, 16, v197
    v_and_b32 v217, 0xffff0000, v197
    v_lshlrev_b32 v218, 16, v198
    v_and_b32 v219, 0xffff0000, v198
    v_lshlrev_b32 v220, 16, v200
    v_and_b32 v221, 0xffff0000, v200
    v_lshlrev_b32 v222, 16, v201
    v_and_b32 v223, 0xffff0000, v201
    v_pk_add_f32 v[160:161], v[160:161], v[208:209]
    v_pk_add_f32 v[162:163], v[162:163], v[210:211]
    v_pk_add_f32 v[164:165], v[164:165], v[212:213]
    v_pk_add_f32 v[166:167], v[166:167], v[214:215]
    v_pk_add_f32 v[168:169], v[168:169], v[216:217]
    v_pk_add_f32 v[170:171], v[170:171], v[218:219]
    v_pk_add_f32 v[172:173], v[172:173], v[220:221]
    v_pk_add_f32 v[174:175], v[174:175], v[222:223]
    s_waitcnt lgkmcnt(0)
    v_pk_add_f32 v[160:161], v[160:161], v[24:25]
    v_pk_add_f32 v[162:163], v[162:163], v[26:27]
    v_pk_add_f32 v[164:165], v[164:165], v[28:29]
    v_pk_add_f32 v[166:167], v[166:167], v[30:31]
    v_pk_add_f32 v[168:169], v[168:169], v[32:33]
    v_pk_add_f32 v[170:171], v[170:171], v[34:35]
    v_pk_add_f32 v[172:173], v[172:173], v[36:37]
    v_pk_add_f32 v[174:175], v[174:175], v[38:39]
    v_pk_mul_f32 v[160:161], v[160:161], v[88:89]
    v_pk_mul_f32 v[168:169], v[168:169], v[88:89]
    v_pk_mul_f32 v[162:163], v[162:163], v[90:91]
    v_pk_mul_f32 v[170:171], v[170:171], v[90:91]
    v_pk_mul_f32 v[176:177], v[160:161], s[28:29]
    v_pk_mul_f32 v[184:185], v[168:169], s[28:29]
    v_pk_mul_f32 v[178:179], v[162:163], s[28:29]
    v_pk_mul_f32 v[186:187], v[170:171], s[28:29]
    v_exp_f32 v176, v176
    v_exp_f32 v177, v177
    v_exp_f32 v184, v184
    v_exp_f32 v185, v185
    v_exp_f32 v178, v178
    v_exp_f32 v179, v179
    v_exp_f32 v186, v186
    v_exp_f32 v187, v187
    v_pk_mul_f32 v[160:161], v[160:161], v[72:73]
    v_pk_mul_f32 v[168:169], v[168:169], v[80:81]
    v_pk_mul_f32 v[162:163], v[162:163], v[74:75]
    v_pk_mul_f32 v[170:171], v[170:171], v[82:83]
    v_pk_add_f32 v[176:177], v[176:177], 1.0 op_sel_hi:[1,0]
    v_pk_add_f32 v[184:185], v[184:185], 1.0 op_sel_hi:[1,0]
    v_pk_add_f32 v[178:179], v[178:179], 1.0 op_sel_hi:[1,0]
    v_pk_add_f32 v[186:187], v[186:187], 1.0 op_sel_hi:[1,0]
    v_rcp_f32 v176, v176
    v_rcp_f32 v177, v177
    v_rcp_f32 v184, v184
    v_rcp_f32 v185, v185
    v_rcp_f32 v178, v178
    v_rcp_f32 v179, v179
    v_rcp_f32 v186, v186
    v_rcp_f32 v187, v187
    v_pk_fma_f32 v[176:177], v[176:177], v[160:161], v[56:57]
    buffer_store_dword v176, v116, s[16:19], 0 offen nt
    buffer_store_dword v177, v116, s[16:19], 0 offen offset:1792 nt
    v_pk_fma_f32 v[184:185], v[184:185], v[168:169], v[64:65]
    buffer_store_dword v184, v116, s[16:19], 0 offen offset:64 nt
    buffer_store_dword v185, v116, s[16:19], 0 offen offset:1856 nt
    v_pk_fma_f32 v[178:179], v[178:179], v[162:163], v[58:59]
    buffer_store_dword v178, v116, s[16:19], s33 offen nt
    buffer_store_dword v179, v116, s[16:19], s33 offen offset:1792 nt
    v_pk_fma_f32 v[186:187], v[186:187], v[170:171], v[66:67]
    buffer_store_dword v186, v116, s[16:19], s33 offen offset:64 nt
    buffer_store_dword v187, v116, s[16:19], s33 offen offset:1856 nt
    v_pk_mul_f32 v[164:165], v[164:165], v[92:93]
    v_pk_mul_f32 v[172:173], v[172:173], v[92:93]
    v_pk_mul_f32 v[166:167], v[166:167], v[94:95]
    v_pk_mul_f32 v[174:175], v[174:175], v[94:95]
    v_pk_mul_f32 v[180:181], v[164:165], s[28:29]
    v_pk_mul_f32 v[188:189], v[172:173], s[28:29]
    v_pk_mul_f32 v[182:183], v[166:167], s[28:29]
    v_pk_mul_f32 v[190:191], v[174:175], s[28:29]
    v_exp_f32 v180, v180
    v_exp_f32 v181, v181
    v_exp_f32 v188, v188
    v_exp_f32 v189, v189
    v_exp_f32 v182, v182
    v_exp_f32 v183, v183
    v_exp_f32 v190, v190
    v_exp_f32 v191, v191
    v_pk_mul_f32 v[164:165], v[164:165], v[76:77]
    v_pk_mul_f32 v[172:173], v[172:173], v[84:85]
    v_pk_mul_f32 v[166:167], v[166:167], v[78:79]
    v_pk_mul_f32 v[174:175], v[174:175], v[86:87]
    v_pk_add_f32 v[180:181], v[180:181], 1.0 op_sel_hi:[1,0]
    v_pk_add_f32 v[188:189], v[188:189], 1.0 op_sel_hi:[1,0]
    v_pk_add_f32 v[182:183], v[182:183], 1.0 op_sel_hi:[1,0]
    v_pk_add_f32 v[190:191], v[190:191], 1.0 op_sel_hi:[1,0]
    v_rcp_f32 v180, v180
    v_rcp_f32 v181, v181
    v_rcp_f32 v188, v188
    v_rcp_f32 v189, v189
    v_rcp_f32 v182, v182
    v_rcp_f32 v183, v183
    v_rcp_f32 v190, v190
    v_rcp_f32 v191, v191
    v_pk_fma_f32 v[180:181], v[180:181], v[164:165], v[60:61]
    buffer_store_dword v180, v116, s[16:19], s36 offen nt
    buffer_store_dword v181, v116, s[16:19], s36 offen offset:1792 nt
    v_pk_fma_f32 v[188:189], v[188:189], v[172:173], v[68:69]
    buffer_store_dword v188, v116, s[16:19], s36 offen offset:64 nt
    buffer_store_dword v189, v116, s[16:19], s36 offen offset:1856 nt
    v_pk_fma_f32 v[182:183], v[182:183], v[166:167], v[62:63]
    buffer_store_dword v182, v116, s[16:19], s37 offen nt
    buffer_store_dword v183, v116, s[16:19], s37 offen offset:1792 nt
    v_pk_fma_f32 v[190:191], v[190:191], v[174:175], v[70:71]
    buffer_store_dword v190, v116, s[16:19], s37 offen offset:64 nt
    buffer_store_dword v191, v116, s[16:19], s37 offen offset:1856 nt
    s_cmp_lg_u32 s5, 15
    s_cbranch_scc1 K_nobump
    s_or_b32 s28, s6, s4
    s_cmp_lg_u32 s28, 0
    s_cbranch_scc1 K_nobump
    v_mov_b32 v8, 0
    v_mov_b32 v9, s84
    s_mov_b32 s28, 18591744
    s_mov_b64 exec, 1
    buffer_store_dword v9, v8, s[20:23], s28 offen sc1
    s_mov_b64 exec, -1
K_nobump:
    s_endpgm
PX_15:
    s_mov_b32 s95, 0
SP_22:
    ds_read_b32 v121, v6 offset:48
    s_waitcnt lgkmcnt(0)
    v_readfirstlane_b32 s82, v121
    s_cmp_lg_u32 s82, 0
    s_cbranch_scc1 SP_22_ok
    s_add_u32 s95, s95, 1
    s_cmp_lt_u32 s95, 2097152
    s_cbranch_scc1 SP_22
SP_22_ok:
    ds_read_b128 v[144:147], v5 offset:16384
    ds_read_b128 v[148:151], v5 offset:17408
    ds_read_b128 v[152:155], v5 offset:18432
    ds_read_b128 v[156:159], v5 offset:19456
    s_waitcnt lgkmcnt(0)
    s_branch PX_15_r
CP_8:
    s_mov_b32 s95, 0
SP_23:
    ds_read_b32 v121, v8 offset:88
    s_waitcnt lgkmcnt(0)
    v_readfirstlane_b32 s82, v121
    s_cmp_ge_u32 s82, 4
    s_cbranch_scc1 SP_23_ok
    s_add_u32 s95, s95, 1
    s_cmp_lt_u32 s95, 2097152
    s_cbranch_scc1 SP_23
SP_23_ok:
    s_branch CP_8_r
WL_13:
    s_mov_b32 s95, 0
SP_24:
    ds_read_b32 v121, v9 offset:112
    s_waitcnt lgkmcnt(0)
    v_readfirstlane_b32 s82, v121
    s_cmp_lg_u32 s82, 0
    s_cbranch_scc1 SP_24_ok
    s_add_u32 s95, s95, 1
    s_cmp_lt_u32 s95, 2097152
    s_cbranch_scc1 SP_24
SP_24_ok:
    s_branch WL_13_r
YX_14:
    s_mov_b32 s95, 0
SP_25:
    ds_read_b32 v121, v8 offset:84
    s_waitcnt lgkmcnt(0)
    v_readfirstlane_b32 s82, v121
    s_cmp_ge_u32 s82, 4
    s_cbranch_scc1 SP_25_ok
    s_add_u32 s95, s95, 1
    s_cmp_lt_u32 s95, 2097152
    s_cbranch_scc1 SP_25
SP_25_ok:
    s_branch YX_14_r
YD_16:
    s_mov_b32 s95, 0
SP_26:
    ds_read_b32 v121, v19 offset:128
    s_waitcnt lgkmcnt(0)
    v_readfirstlane_b32 s82, v121
    s_cmp_lg_u32 s82, 0
    s_cbranch_scc1 SP_26_ok
    s_add_u32 s95, s95, 1
    s_cmp_lt_u32 s95, 2097152
    s_cbranch_scc1 SP_26
SP_26_ok:
    s_branch YD_16_r
RX_17:
    s_mov_b32 s95, 0
SP_27:
    ds_read_b32 v121, v6 offset:64
    s_waitcnt lgkmcnt(0)
    v_readfirstlane_b32 s82, v121
    s_cmp_lg_u32 s82, 0
    s_cbranch_scc1 SP_27_ok
    s_add_u32 s95, s95, 1
    s_cmp_lt_u32 s95, 2097152
    s_cbranch_scc1 SP_27
SP_27_ok:
    s_branch RX_17_r
K_csslow:
    s_mov_b32 s95, 0
SP_28:
    ds_read_b32 v121, v19 offset:16
    ds_read_b32 v72, v123 offset:0
    ds_read_b32 v73, v123 offset:32
    ds_read_b32 v74, v123 offset:128
    ds_read_b32 v75, v123 offset:160
    ds_read_b32 v76, v123 offset:256
    ds_read_b32 v77, v123 offset:288
    ds_read_b32 v78, v123 offset:384
    ds_read_b32 v79, v123 offset:416
    ds_read_b128 v[56:59], v122 offset:0
    ds_read_b128 v[60:63], v122 offset:64
    ds_read_b128 v[64:67], v122 offset:128
    ds_read_b128 v[68:71], v122 offset:192
    s_waitcnt lgkmcnt(0)
    v_readfirstlane_b32 s97, v121
    s_cmp_lg_u32 s97, 0
    s_cbranch_scc1 SP_28_ok
    s_sleep 1
    s_add_u32 s95, s95, 1
    s_cmp_lt_u32 s95, 2097152
    s_cbranch_scc1 SP_28
SP_28_ok:
    s_branch K_csok
PG_1:
    s_mov_b32 s95, 0
SP_29:
    ds_read_b32 v16, v17
    s_waitcnt lgkmcnt(0)
    v_cmp_gt_u32 vcc, 1, v16
    s_nop 1
    s_cmp_eq_u64 vcc, 0
    s_cbranch_scc1 SP_29_ok
    s_add_u32 s95, s95, 1
    s_cmp_lt_u32 s95, 2097152
    s_cbranch_scc1 SP_29
SP_29_ok:
    s_branch PG_1_r
PG_2:
    s_mov_b32 s95, 0
SP_30:
    ds_read_b32 v16, v17
    s_waitcnt lgkmcnt(0)
    v_cmp_gt_u32 vcc, 2, v16
    s_nop 1
    s_cmp_eq_u64 vcc, 0
    s_cbranch_scc1 SP_30_ok
    s_add_u32 s95, s95, 1
    s_cmp_lt_u32 s95, 2097152
    s_cbranch_scc1 SP_30
SP_30_ok:
    s_branch PG_2_r
PG_3:
    s_mov_b32 s95, 0
SP_31:
    ds_read_b32 v16, v17
    s_waitcnt lgkmcnt(0)
    v_cmp_gt_u32 vcc, 3, v16
    s_nop 1
    s_cmp_eq_u64 vcc, 0
    s_cbranch_scc1 SP_31_ok
    s_add_u32 s95, s95, 1
    s_cmp_lt_u32 s95, 2097152
    s_cbranch_scc1 SP_31
SP_31_ok:
    s_branch PG_3_r
PG_4:
    s_mov_b32 s95, 0
SP_32:
    ds_read_b32 v16, v17
    s_waitcnt lgkmcnt(0)
    v_cmp_gt_u32 vcc, 4, v16
    s_nop 1
    s_cmp_eq_u64 vcc, 0
    s_cbranch_scc1 SP_32_ok
    s_add_u32 s95, s95, 1
    s_cmp_lt_u32 s95, 2097152
    s_cbranch_scc1 SP_32
SP_32_ok:
    s_branch PG_4_r
PG_5:
    s_mov_b32 s95, 0
SP_33:
    ds_read_b32 v16, v17
    s_waitcnt lgkmcnt(0)
    v_cmp_gt_u32 vcc, 5, v16
    s_nop 1
    s_cmp_eq_u64 vcc, 0
    s_cbranch_scc1 SP_33_ok
    s_add_u32 s95, s95, 1
    s_cmp_lt_u32 s95, 2097152
    s_cbranch_scc1 SP_33
SP_33_ok:
    s_branch PG_5_r
PG_6:
    s_mov_b32 s95, 0
SP_34:
    ds_read_b32 v16, v17
    s_waitcnt lgkmcnt(0)
    v_cmp_gt_u32 vcc, 6, v16
    s_nop 1
    s_cmp_eq_u64 vcc, 0
    s_cbranch_scc1 SP_34_ok
    s_add_u32 s95, s95, 1
    s_cmp_lt_u32 s95, 2097152
    s_cbranch_scc1 SP_34
SP_34_ok:
    s_branch PG_6_r
PG_7:
    s_mov_b32 s95, 0
SP_35:
    ds_read_b32 v16, v17
    s_waitcnt lgkmcnt(0)
    v_cmp_gt_u32 vcc, 7, v16
    s_nop 1
    s_cmp_eq_u64 vcc, 0
    s_cbranch_scc1 SP_35_ok
    s_add_u32 s95, s95, 1
    s_cmp_lt_u32 s95, 2097152
    s_cbranch_scc1 SP_35
SP_35_ok:
    s_branch PG_7_r
K_S:
    s_setprio 3
    s_bfe_u32 s85, s2, 0x10002
    s_mul_i32 s6, s85, 7
    s_add_u32 s6, s6, s91
    s_lshl_b32 s79, s4, 11
    s_add_u32 s79, s79, 114688
    v_and_b32 v20, 31, v0
    v_bfe_u32 v22, v0, 1, 3
    v_xor_b32 v22, v22, v21
    v_lshlrev_b32 v20, 7, v20
    v_and_b32 v1, 19, v0
    v_bfe_u32 v2, v0, 2, 1
    v_lshl_add_u32 v1, v2, 3, v1
    v_bfe_u32 v2, v0, 3, 1
    v_lshl_add_u32 v1, v2, 2, v1
    s_lshl_b32 s30, s6, 5
    v_add_u32 v1, s30, v1
    v_lshlrev_b32 v1, 1, v1
    v_and_b32 v1, -4, v1
    s_lshl_b32 s30, s91, 7
    s_and_b32 s31, s4, 2
    s_lshl_b32 s31, s31, 5
    s_add_u32 s30, s30, s31
    v_and_b32 v7, 14, v0
    v_lshl_add_u32 v7, v7, 1, s30
    v_mov_b32 v247, 0
    v_add_u32 v23, s89, v20
    v_add_u32 v24, 114688, v20
    s_lshl_b32 s31, s4, 1
    v_xor_b32 v6, s31, v22
    v_xor_b32 v5, 0, v6
    v_lshl_add_u32 v10, v5, 4, v23
    v_add_u32 v14, 0x10000, v10
    v_lshl_add_u32 v240, v5, 4, v24
    v_xor_b32 v5, 2, v6
    v_lshl_add_u32 v11, v5, 4, v23
    v_add_u32 v15, 0x10000, v11
    v_lshl_add_u32 v241, v5, 4, v24
    v_xor_b32 v5, 4, v6
    v_lshl_add_u32 v12, v5, 4, v23
    v_add_u32 v16, 0x10000, v12
    v_lshl_add_u32 v242, v5, 4, v24
    v_xor_b32 v5, 6, v6
    v_lshl_add_u32 v13, v5, 4, v23
    v_add_u32 v17, 0x10000, v13
    v_lshl_add_u32 v243, v5, 4, v24
    s_mov_b32 s94, 0x3f803f80
    v_mov_b32 v34, 0
    v_mov_b32 v35, 0
    v_mov_b32 v36, 0
    v_mov_b32 v37, 0
    s_mov_b32 s22, 18591872
    s_mov_b32 s23, 0x20000
    s_mov_b32 s82, 18591744
    v_mov_b32 v18, 162816
    v_mov_b32 v19, 1
    s_lshl_b32 s30, s4, 2
    s_add_u32 s30, s30, 162816
    v_mov_b32 v20, s30
    s_waitcnt lgkmcnt(0)
    s_mov_b32 s20, s62
    s_and_b32 s21, s63, 0xffff
    v_mov_b32 v138, v1
    v_mov_b32 v139, v7
    global_load_dword v244, v138, s[34:35]
    global_load_dword v245, v138, s[36:37]
    global_load_dword v246, v138, s[46:47]
    global_load_dword v142, v139, s[48:49]
    global_load_dword v139, v139, s[48:49] offset:32
    s_mov_b32 s82, 18591744
    s_mov_b64 exec, 1
    buffer_load_dword v247, v247, s[20:23], s82 offen sc1
    s_mov_b64 exec, -1
    s_lshr_b32 s7, s2, 6
    s_and_b32 s10, s2, 3
    s_sub_u32 s7, s7, s10
    s_cselect_b32 s10, 7, 0
    s_add_u32 s7, s7, s10
    s_sub_u32 s30, s91, s7
    s_cselect_b32 s10, 7, 0
    s_add_u32 s30, s30, s10
    s_lshl_b32 s30, s30, 14
    s_lshl_b32 s31, s85, 13
    s_add_u32 s30, s30, s31
    s_and_b32 s31, s4, 1
    s_lshl_b32 s31, s31, 12
    s_add_u32 s30, s30, s31
    v_lshrrev_b32 v4, 2, v0
    v_lshrrev_b32 v5, 3, v0
    v_lshlrev_b32 v4, 7, v4
    v_bfe_u32 v7, v0, 1, 1
    s_and_b32 s31, s4, 2
    s_lshl_b32 s31, s31, 1
    v_add_u32 v7, s31, v7
    v_xor_b32 v7, v7, v5
    v_lshl_add_u32 v4, v7, 4, v4
    v_and_b32 v7, 1, v0
    v_lshl_add_u32 v4, v7, 3, v4
    v_add_u32 v254, s30, v4
    v_xor_b32 v255, 32, v254
    v_lshlrev_b32 v8, 4, v7
    v_xor_b32 v8, 16, v8
    s_bitcmp1_b32 s4, 0
    s_cselect_b64 s[64:65], -1, 0
    s_bitcmp1_b32 s4, 1
    s_cselect_b64 s[66:67], -1, 0
    s_mov_b32 s68, 0
    s_mov_b32 s69, -1
    s_lshr_b32 s87, s4, 1
    s_lshl_b32 s73, s85, 6
    s_barrier
    ds_read_b128 v[144:147], v10 offset:0
    ds_read_b128 v[148:151], v240 offset:0
    ds_read_b128 v[152:155], v240 offset:4096
    ds_read_b128 v[156:159], v11 offset:0
    ds_read_b128 v[160:163], v241 offset:0
    ds_read_b128 v[164:167], v241 offset:4096
    ds_read_b128 v[168:171], v12 offset:0
    ds_read_b128 v[172:175], v242 offset:0
    ds_read_b128 v[176:179], v242 offset:4096
    ds_read_b128 v[180:183], v13 offset:0
    ds_read_b128 v[184:187], v243 offset:0
    ds_read_b128 v[188:191], v243 offset:4096
    s_waitcnt lgkmcnt(0)
    s_barrier
    v_mfma_f32_32x32x16_bf16 v[40:55], v[144:147], v[148:151], 0
    ds_read_b128 v[192:195], v10 offset:16384
    ds_read_b128 v[196:199], v240 offset:8192
    v_bfe_u32 v1, v0, 2, 1
    v_lshlrev_b32 v1, 4, v1
    v_mfma_f32_32x32x16_bf16 v[40:55], v[156:159], v[160:163], v[40:55]
    ds_read_b128 v[200:203], v240 offset:12288
    ds_read_b128 v[204:207], v11 offset:16384
    v_bfe_u32 v2, v0, 3, 2
    v_lshl_add_u32 v1, v2, 2, v1
    v_mfma_f32_32x32x16_bf16 v[40:55], v[168:171], v[172:175], v[40:55]
    ds_read_b128 v[208:211], v241 offset:8192
    ds_read_b128 v[212:215], v241 offset:12288
    v_and_b32 v2, 3, v0
    v_add_u32 v1, v1, v2
    v_mfma_f32_32x32x16_bf16 v[40:55], v[180:183], v[184:187], v[40:55]
    ds_read_b128 v[216:219], v12 offset:16384
    ds_read_b128 v[220:223], v242 offset:8192
    v_lshlrev_b32 v2, 4, v21
    v_sub_u32 v1, v1, v2
    v_mfma_f32_32x32x16_bf16 v[56:71], v[144:147], v[152:155], 0
    ds_read_b128 v[224:227], v242 offset:12288
    ds_read_b128 v[228:231], v13 offset:16384
    v_and_b32 v2, 1, v1
    v_lshlrev_b32 v2, 4, v2
    v_mfma_f32_32x32x16_bf16 v[56:71], v[156:159], v[164:167], v[56:71]
    ds_read_b128 v[232:235], v243 offset:8192
    ds_read_b128 v[236:239], v243 offset:12288
    v_mov_b32 v4, 0x3f80
    v_lshlrev_b32 v2, v2, v4
    v_mfma_f32_32x32x16_bf16 v[56:71], v[168:171], v[176:179], v[56:71]
    v_ashrrev_i32 v1, 1, v1
    v_cmp_eq_u32 vcc, 0, v1
    v_cmp_eq_u32 s[70:71], 1, v1
    s_nop 0
    v_mfma_f32_32x32x16_bf16 v[56:71], v[180:183], v[188:191], v[56:71]
    v_cndmask_b32 v72, 0, v2, vcc
    v_cndmask_b32 v73, 0, v2, s[70:71]
    v_cmp_eq_u32 vcc, 2, v1
    v_cmp_eq_u32 s[70:71], 3, v1
    v_dot2c_f32_bf16 v37, v144, v144
    v_dot2c_f32_bf16 v36, s94, v144
    v_dot2c_f32_bf16 v37, v145, v145
    v_dot2c_f32_bf16 v36, s94, v145
    v_dot2c_f32_bf16 v37, v146, v146
    v_dot2c_f32_bf16 v36, s94, v146
    v_dot2c_f32_bf16 v37, v147, v147
    v_dot2c_f32_bf16 v36, s94, v147
    v_dot2c_f32_bf16 v37, v156, v156
    v_dot2c_f32_bf16 v36, s94, v156
    v_dot2c_f32_bf16 v37, v157, v157
    v_dot2c_f32_bf16 v36, s94, v157
    v_dot2c_f32_bf16 v37, v158, v158
    v_dot2c_f32_bf16 v36, s94, v158
    v_dot2c_f32_bf16 v37, v159, v159
    v_dot2c_f32_bf16 v36, s94, v159
    v_dot2c_f32_bf16 v37, v168, v168
    v_dot2c_f32_bf16 v36, s94, v168
    v_dot2c_f32_bf16 v37, v169, v169
    v_dot2c_f32_bf16 v36, s94, v169
    v_dot2c_f32_bf16 v37, v170, v170
    v_dot2c_f32_bf16 v36, s94, v170
    v_dot2c_f32_bf16 v37, v171, v171
    v_dot2c_f32_bf16 v36, s94, v171
    v_dot2c_f32_bf16 v37, v180, v180
    v_dot2c_f32_bf16 v36, s94, v180
    v_dot2c_f32_bf16 v37, v181, v181
    v_dot2c_f32_bf16 v36, s94, v181
    v_dot2c_f32_bf16 v37, v182, v182
    v_dot2c_f32_bf16 v36, s94, v182
    v_dot2c_f32_bf16 v37, v183, v183
    v_dot2c_f32_bf16 v36, s94, v183
    v_dot2c_f32_bf16 v34, s94, v148
    v_dot2c_f32_bf16 v35, s94, v152
    v_dot2c_f32_bf16 v34, s94, v149
    v_dot2c_f32_bf16 v35, s94, v153
    v_dot2c_f32_bf16 v34, s94, v150
    v_dot2c_f32_bf16 v35, s94, v154
    v_dot2c_f32_bf16 v34, s94, v151
    v_dot2c_f32_bf16 v35, s94, v155
    s_waitcnt vmcnt(0)
    v_readfirstlane_b32 s84, v247
    s_add_u32 s84, s84, 1
    s_max_u32 s84, s84, 1
    s_getreg_b32 s74, hwreg(HW_REG_XCC_ID, 0, 4)
    s_lshl_b32 s78, s5, 1
    s_add_u32 s78, s78, s85
    s_lshl_b32 s78, s78, 10
    s_add_u32 s78, s78, 18493440
    s_add_u32 s75, s78, 65536
    s_cmp_lg_u32 s4, 0
    s_cbranch_scc1 K_noxid
    s_lshl_b32 s31, s91, 7
    v_mov_b32 v251, s31
    v_mov_b32 v252, s74
    v_mov_b32 v253, s84
    s_mov_b64 exec, 1
    buffer_store_dwordx2 v[252:253], v251, s[20:23], s75 offen sc1
    s_mov_b64 exec, -1
K_noxid:
    s_waitcnt lgkmcnt(0)
    s_barrier
    v_mfma_f32_32x32x16_bf16 v[56:71], v[192:195], v[200:203], v[56:71]
    ds_read_b128 v[144:147], v10 offset:32768
    ds_read_b128 v[148:151], v240 offset:16384
    s_nop 0
    v_cndmask_b32 v74, 0, v2, vcc
    v_mfma_f32_32x32x16_bf16 v[56:71], v[204:207], v[212:215], v[56:71]
    ds_read_b128 v[152:155], v240 offset:20480
    ds_read_b128 v[156:159], v11 offset:32768
    v_cndmask_b32 v75, 0, v2, s[70:71]
    v_cmp_eq_u32 vcc, 4, v1
    v_mfma_f32_32x32x16_bf16 v[56:71], v[216:219], v[224:227], v[56:71]
    ds_read_b128 v[160:163], v241 offset:16384
    ds_read_b128 v[164:167], v241 offset:20480
    v_cmp_eq_u32 s[70:71], 5, v1
    s_nop 0
    v_mfma_f32_32x32x16_bf16 v[56:71], v[228:231], v[236:239], v[56:71]
    ds_read_b128 v[168:171], v12 offset:32768
    ds_read_b128 v[172:175], v242 offset:16384
    v_cndmask_b32 v76, 0, v2, vcc
    v_cndmask_b32 v77, 0, v2, s[70:71]
    v_mfma_f32_32x32x16_bf16 v[40:55], v[192:195], v[196:199], v[40:55]
    ds_read_b128 v[176:179], v242 offset:20480
    ds_read_b128 v[180:183], v13 offset:32768
    v_cmp_eq_u32 vcc, 6, v1
    v_cmp_eq_u32 s[70:71], 7, v1
    v_mfma_f32_32x32x16_bf16 v[40:55], v[204:207], v[208:211], v[40:55]
    ds_read_b128 v[184:187], v243 offset:16384
    ds_read_b128 v[188:191], v243 offset:20480
    s_nop 0
    v_cndmask_b32 v78, 0, v2, vcc
    v_mfma_f32_32x32x16_bf16 v[40:55], v[216:219], v[220:223], v[40:55]
    v_cndmask_b32 v79, 0, v2, s[70:71]
    v_lshlrev_b32 v244, v8, v244
    v_and_b32 v244, 0xffff0000, v244
    v_lshlrev_b32 v245, v8, v245
    v_mfma_f32_32x32x16_bf16 v[40:55], v[228:231], v[232:235], v[40:55]
    v_and_b32 v245, 0xffff0000, v245
    v_lshlrev_b32 v246, v8, v246
    v_and_b32 v246, 0xffff0000, v246
    v_lshlrev_b32 v142, v8, v142
    v_dot2c_f32_bf16 v37, v192, v192
    v_dot2c_f32_bf16 v36, s94, v192
    v_dot2c_f32_bf16 v37, v193, v193
    v_dot2c_f32_bf16 v36, s94, v193
    v_dot2c_f32_bf16 v37, v194, v194
    v_dot2c_f32_bf16 v36, s94, v194
    v_dot2c_f32_bf16 v37, v195, v195
    v_dot2c_f32_bf16 v36, s94, v195
    v_dot2c_f32_bf16 v37, v204, v204
    v_dot2c_f32_bf16 v36, s94, v204
    v_dot2c_f32_bf16 v37, v205, v205
    v_dot2c_f32_bf16 v36, s94, v205
    v_dot2c_f32_bf16 v37, v206, v206
    v_dot2c_f32_bf16 v36, s94, v206
    v_dot2c_f32_bf16 v37, v207, v207
    v_dot2c_f32_bf16 v36, s94, v207
    v_dot2c_f32_bf16 v37, v216, v216
    v_dot2c_f32_bf16 v36, s94, v216
    v_dot2c_f32_bf16 v37, v217, v217
    v_dot2c_f32_bf16 v36, s94, v217
    v_dot2c_f32_bf16 v37, v218, v218
    v_dot2c_f32_bf16 v36, s94, v218
    v_dot2c_f32_bf16 v37, v219, v219
    v_dot2c_f32_bf16 v36, s94, v219
    v_dot2c_f32_bf16 v37, v228, v228
    v_dot2c_f32_bf16 v36, s94, v228
    v_dot2c_f32_bf16 v37, v229, v229
    v_dot2c_f32_bf16 v36, s94, v229
    v_dot2c_f32_bf16 v37, v230, v230
    v_dot2c_f32_bf16 v36, s94, v230
    v_dot2c_f32_bf16 v37, v231, v231
    v_dot2c_f32_bf16 v36, s94, v231
    v_dot2c_f32_bf16 v34, s94, v196
    v_dot2c_f32_bf16 v35, s94, v200
    v_dot2c_f32_bf16 v34, s94, v197
    v_dot2c_f32_bf16 v35, s94, v201
    v_dot2c_f32_bf16 v34, s94, v198
    v_dot2c_f32_bf16 v35, s94, v202
    v_dot2c_f32_bf16 v34, s94, v199
    v_dot2c_f32_bf16 v35, s94, v203
    s_waitcnt lgkmcnt(0)
    s_barrier
    v_mfma_f32_32x32x16_bf16 v[40:55], v[144:147], v[148:151], v[40:55]
    ds_read_b128 v[192:195], v10 offset:49152
    ds_read_b128 v[196:199], v240 offset:24576
    v_and_b32 v142, 0xffff0000, v142
    v_lshlrev_b32 v139, v8, v139
    v_mfma_f32_32x32x16_bf16 v[40:55], v[156:159], v[160:163], v[40:55]
    ds_read_b128 v[200:203], v240 offset:28672
    ds_read_b128 v[204:207], v11 offset:49152
    v_and_b32 v139, 0xffff0000, v139
    v_mul_f32 v246, 1069066811, v246
    v_mfma_f32_32x32x16_bf16 v[40:55], v[168:171], v[172:175], v[40:55]
    ds_read_b128 v[208:211], v241 offset:24576
    ds_read_b128 v[212:215], v241 offset:28672
    v_exp_f32 v246, v246
    s_nop 0
    v_mfma_f32_32x32x16_bf16 v[40:55], v[180:183], v[184:187], v[40:55]
    ds_read_b128 v[216:219], v12 offset:49152
    ds_read_b128 v[220:223], v242 offset:24576
    v_cvt_pk_bf16_f32 v246, v246, v246
    v_and_b32 v246, 0xffff0000, v246
    v_mfma_f32_32x32x16_bf16 v[56:71], v[144:147], v[152:155], v[56:71]
    ds_read_b128 v[224:227], v242 offset:28672
    ds_read_b128 v[228:231], v13 offset:49152
    v_mul_f32 v5, v246, v244
    v_mul_f32 v6, v246, v245
    v_mfma_f32_32x32x16_bf16 v[56:71], v[156:159], v[164:167], v[56:71]
    ds_read_b128 v[232:235], v243 offset:24576
    ds_read_b128 v[236:239], v243 offset:28672
    v_mul_f32 v5, 1069066811, v5
    v_exp_f32 v5, v5
    v_mfma_f32_32x32x16_bf16 v[56:71], v[168:171], v[176:179], v[56:71]
    v_mul_f32 v6, 0.15915494, v6
    v_rndne_f32 v9, v6
    v_sub_f32 v6, v6, v9
    v_cos_f32 v22, v6
    v_mfma_f32_32x32x16_bf16 v[56:71], v[180:183], v[188:191], v[56:71]
    v_sin_f32 v23, v6
    s_nop 0
    v_mul_f32 v22, v22, v5
    v_mul_f32 v23, v23, v5
    v_dot2c_f32_bf16 v37, v144, v144
    v_dot2c_f32_bf16 v36, s94, v144
    v_dot2c_f32_bf16 v37, v145, v145
    v_dot2c_f32_bf16 v36, s94, v145
    v_dot2c_f32_bf16 v37, v146, v146
    v_dot2c_f32_bf16 v36, s94, v146
    v_dot2c_f32_bf16 v37, v147, v147
    v_dot2c_f32_bf16 v36, s94, v147
    v_dot2c_f32_bf16 v37, v156, v156
    v_dot2c_f32_bf16 v36, s94, v156
    v_dot2c_f32_bf16 v37, v157, v157
    v_dot2c_f32_bf16 v36, s94, v157
    v_dot2c_f32_bf16 v37, v158, v158
    v_dot2c_f32_bf16 v36, s94, v158
    v_dot2c_f32_bf16 v37, v159, v159
    v_dot2c_f32_bf16 v36, s94, v159
    v_dot2c_f32_bf16 v37, v168, v168
    v_dot2c_f32_bf16 v36, s94, v168
    v_dot2c_f32_bf16 v37, v169, v169
    v_dot2c_f32_bf16 v36, s94, v169
    v_dot2c_f32_bf16 v37, v170, v170
    v_dot2c_f32_bf16 v36, s94, v170
    v_dot2c_f32_bf16 v37, v171, v171
    v_dot2c_f32_bf16 v36, s94, v171
    v_dot2c_f32_bf16 v37, v180, v180
    v_dot2c_f32_bf16 v36, s94, v180
    v_dot2c_f32_bf16 v37, v181, v181
    v_dot2c_f32_bf16 v36, s94, v181
    v_dot2c_f32_bf16 v37, v182, v182
    v_dot2c_f32_bf16 v36, s94, v182
    v_dot2c_f32_bf16 v37, v183, v183
    v_dot2c_f32_bf16 v36, s94, v183
    v_dot2c_f32_bf16 v34, s94, v148
    v_dot2c_f32_bf16 v35, s94, v152
    v_dot2c_f32_bf16 v34, s94, v149
    v_dot2c_f32_bf16 v35, s94, v153
    v_dot2c_f32_bf16 v34, s94, v150
    v_dot2c_f32_bf16 v35, s94, v154
    v_dot2c_f32_bf16 v34, s94, v151
    v_dot2c_f32_bf16 v35, s94, v155
    s_waitcnt lgkmcnt(0)
    s_barrier
    v_mfma_f32_32x32x16_bf16 v[56:71], v[192:195], v[200:203], v[56:71]
    ds_read_b128 v[144:147], v14 offset:0
    ds_read_b128 v[148:151], v240 offset:32768
    v_mul_f32 v5, v244, v244
    v_fma_f32 v5, v245, v245, v5
    v_mfma_f32_32x32x16_bf16 v[56:71], v[204:207], v[212:215], v[56:71]
    ds_read_b128 v[152:155], v240 offset:36864
    ds_read_b128 v[156:159], v15 offset:0
    v_rcp_f32 v5, v5
    v_add_f32 v6, -1.0, v22
    v_mfma_f32_32x32x16_bf16 v[56:71], v[216:219], v[224:227], v[56:71]
    ds_read_b128 v[160:163], v241 offset:32768
    ds_read_b128 v[164:167], v241 offset:36864
    v_mul_f32 v30, v6, v244
    v_fma_f32 v30, v23, v245, v30
    v_mfma_f32_32x32x16_bf16 v[56:71], v[228:231], v[236:239], v[56:71]
    ds_read_b128 v[168:171], v16 offset:0
    ds_read_b128 v[172:175], v242 offset:32768
    v_mul_f32 v31, v23, v244
    v_fma_f32 v31, -v6, v245, v31
    v_mfma_f32_32x32x16_bf16 v[40:55], v[192:195], v[196:199], v[40:55]
    ds_read_b128 v[176:179], v242 offset:36864
    ds_read_b128 v[180:183], v17 offset:0
    v_add_f32 v5, v5, v5
    v_mul_f32 v30, v30, v5
    v_mfma_f32_32x32x16_bf16 v[40:55], v[204:207], v[208:211], v[40:55]
    ds_read_b128 v[184:187], v243 offset:32768
    ds_read_b128 v[188:191], v243 offset:36864
    v_mul_f32 v31, v31, v5
    v_xor_b32 v33, 0x80000000, v23
    v_mfma_f32_32x32x16_bf16 v[40:55], v[216:219], v[220:223], v[40:55]
    v_mul_f32 v9, v22, v23
    v_mul_f32 v24, v22, v22
    v_fma_f32 v24, -v23, v23, v24
    v_add_f32 v25, v9, v9
    v_mfma_f32_32x32x16_bf16 v[40:55], v[228:231], v[232:235], v[40:55]
    v_mul_f32 v9, v24, v25
    v_mul_f32 v24, v24, v24
    v_fma_f32 v24, -v25, v25, v24
    v_add_f32 v25, v9, v9
    v_dot2c_f32_bf16 v37, v192, v192
    v_dot2c_f32_bf16 v36, s94, v192
    v_dot2c_f32_bf16 v37, v193, v193
    v_dot2c_f32_bf16 v36, s94, v193
    v_dot2c_f32_bf16 v37, v194, v194
    v_dot2c_f32_bf16 v36, s94, v194
    v_dot2c_f32_bf16 v37, v195, v195
    v_dot2c_f32_bf16 v36, s94, v195
    v_dot2c_f32_bf16 v37, v204, v204
    v_dot2c_f32_bf16 v36, s94, v204
    v_dot2c_f32_bf16 v37, v205, v205
    v_dot2c_f32_bf16 v36, s94, v205
    v_dot2c_f32_bf16 v37, v206, v206
    v_dot2c_f32_bf16 v36, s94, v206
    v_dot2c_f32_bf16 v37, v207, v207
    v_dot2c_f32_bf16 v36, s94, v207
    v_dot2c_f32_bf16 v37, v216, v216
    v_dot2c_f32_bf16 v36, s94, v216
    v_dot2c_f32_bf16 v37, v217, v217
    v_dot2c_f32_bf16 v36, s94, v217
    v_dot2c_f32_bf16 v37, v218, v218
    v_dot2c_f32_bf16 v36, s94, v218
    v_dot2c_f32_bf16 v37, v219, v219
    v_dot2c_f32_bf16 v36, s94, v219
    v_dot2c_f32_bf16 v37, v228, v228
    v_dot2c_f32_bf16 v36, s94, v228
    v_dot2c_f32_bf16 v37, v229, v229
    v_dot2c_f32_bf16 v36, s94, v229
    v_dot2c_f32_bf16 v37, v230, v230
    v_dot2c_f32_bf16 v36, s94, v230
    v_dot2c_f32_bf16 v37, v231, v231
    v_dot2c_f32_bf16 v36, s94, v231
    v_dot2c_f32_bf16 v34, s94, v196
    v_dot2c_f32_bf16 v35, s94, v200
    v_dot2c_f32_bf16 v34, s94, v197
    v_dot2c_f32_bf16 v35, s94, v201
    v_dot2c_f32_bf16 v34, s94, v198
    v_dot2c_f32_bf16 v35, s94, v202
    v_dot2c_f32_bf16 v34, s94, v199
    v_dot2c_f32_bf16 v35, s94, v203
    s_waitcnt lgkmcnt(0)
    s_barrier
    v_mfma_f32_32x32x16_bf16 v[40:55], v[144:147], v[148:151], v[40:55]
    ds_read_b128 v[192:195], v14 offset:16384
    ds_read_b128 v[196:199], v240 offset:0
    v_mul_f32 v9, v24, v25
    v_mul_f32 v24, v24, v24
    v_mfma_f32_32x32x16_bf16 v[40:55], v[156:159], v[160:163], v[40:55]
    ds_read_b128 v[200:203], v240 offset:4096
    ds_read_b128 v[204:207], v15 offset:16384
    v_fma_f32 v24, -v25, v25, v24
    v_add_f32 v25, v9, v9
    v_mfma_f32_32x32x16_bf16 v[40:55], v[168:171], v[172:175], v[40:55]
    ds_read_b128 v[208:211], v241 offset:0
    ds_read_b128 v[212:215], v241 offset:4096
    v_mul_f32 v9, v24, v25
    v_mul_f32 v24, v24, v24
    v_mfma_f32_32x32x16_bf16 v[40:55], v[180:183], v[184:187], v[40:55]
    ds_read_b128 v[216:219], v16 offset:16384
    ds_read_b128 v[220:223], v242 offset:0
    v_fma_f32 v24, -v25, v25, v24
    v_add_f32 v25, v9, v9
    v_mfma_f32_32x32x16_bf16 v[56:71], v[144:147], v[152:155], v[56:71]
    ds_read_b128 v[224:227], v242 offset:4096
    ds_read_b128 v[228:231], v17 offset:16384
    v_cndmask_b32 v28, 1.0, v24, s[68:69]
    v_cndmask_b32 v29, 0, v25, s[68:69]
    v_mfma_f32_32x32x16_bf16 v[56:71], v[156:159], v[164:167], v[56:71]
    ds_read_b128 v[232:235], v243 offset:0
    ds_read_b128 v[236:239], v243 offset:4096
    v_mul_f32 v9, v24, v25
    v_mul_f32 v26, v24, v24
    v_mfma_f32_32x32x16_bf16 v[56:71], v[168:171], v[176:179], v[56:71]
    v_fma_f32 v26, -v25, v25, v26
    s_lshl_b32 s72, s4, 2
    s_add_u32 s72, s72, 156672
    v_lshl_add_u32 v248, v0, 4, s72
    v_mfma_f32_32x32x16_bf16 v[56:71], v[180:183], v[188:191], v[56:71]
    v_bfe_u32 v249, v0, 2, 1
    v_lshlrev_b32 v249, 4, v249
    v_bfe_u32 v2, v0, 3, 2
    v_lshl_add_u32 v249, v2, 2, v249
    v_dot2c_f32_bf16 v37, v144, v144
    v_dot2c_f32_bf16 v36, s94, v144
    v_dot2c_f32_bf16 v37, v145, v145
    v_dot2c_f32_bf16 v36, s94, v145
    v_dot2c_f32_bf16 v37, v146, v146
    v_dot2c_f32_bf16 v36, s94, v146
    v_dot2c_f32_bf16 v37, v147, v147
    v_dot2c_f32_bf16 v36, s94, v147
    v_dot2c_f32_bf16 v37, v156, v156
    v_dot2c_f32_bf16 v36, s94, v156
    v_dot2c_f32_bf16 v37, v157, v157
    v_dot2c_f32_bf16 v36, s94, v157
    v_dot2c_f32_bf16 v37, v158, v158
    v_dot2c_f32_bf16 v36, s94, v158
    v_dot2c_f32_bf16 v37, v159, v159
    v_dot2c_f32_bf16 v36, s94, v159
    v_dot2c_f32_bf16 v37, v168, v168
    v_dot2c_f32_bf16 v36, s94, v168
    v_dot2c_f32_bf16 v37, v169, v169
    v_dot2c_f32_bf16 v36, s94, v169
    v_dot2c_f32_bf16 v37, v170, v170
    v_dot2c_f32_bf16 v36, s94, v170
    v_dot2c_f32_bf16 v37, v171, v171
    v_dot2c_f32_bf16 v36, s94, v171
    v_dot2c_f32_bf16 v37, v180, v180
    v_dot2c_f32_bf16 v36, s94, v180
    v_dot2c_f32_bf16 v37, v181, v181
    v_dot2c_f32_bf16 v36, s94, v181
    v_dot2c_f32_bf16 v37, v182, v182
    v_dot2c_f32_bf16 v36, s94, v182
    v_dot2c_f32_bf16 v37, v183, v183
    v_dot2c_f32_bf16 v36, s94, v183
    v_dot2c_f32_bf16 v34, s94, v148
    v_dot2c_f32_bf16 v35, s94, v152
    v_dot2c_f32_bf16 v34, s94, v149
    v_dot2c_f32_bf16 v35, s94, v153
    v_dot2c_f32_bf16 v34, s94, v150
    v_dot2c_f32_bf16 v35, s94, v154
    v_dot2c_f32_bf16 v34, s94, v151
    v_dot2c_f32_bf16 v35, s94, v155
    s_waitcnt lgkmcnt(0)
    s_barrier
    v_mfma_f32_32x32x16_bf16 v[56:71], v[192:195], v[200:203], v[56:71]
    ds_read_b128 v[144:147], v14 offset:32768
    ds_read_b128 v[148:151], v240 offset:8192
    v_and_b32 v2, 3, v0
    v_add_u32 v249, v249, v2
    v_mfma_f32_32x32x16_bf16 v[56:71], v[204:207], v[212:215], v[56:71]
    ds_read_b128 v[152:155], v240 offset:12288
    ds_read_b128 v[156:159], v15 offset:32768
    s_lshl_b32 s72, s4, 7
    s_add_u32 s72, s72, 155648
    v_mfma_f32_32x32x16_bf16 v[56:71], v[216:219], v[224:227], v[56:71]
    ds_read_b128 v[160:163], v241 offset:8192
    ds_read_b128 v[164:167], v241 offset:12288
    v_lshl_add_u32 v249, v249, 2, s72
    v_lshl_add_u32 v249, v21, 9, v249
    v_mfma_f32_32x32x16_bf16 v[56:71], v[228:231], v[236:239], v[56:71]
    ds_read_b128 v[168:171], v16 offset:32768
    ds_read_b128 v[172:175], v242 offset:8192
    v_lshl_add_u32 v3, v21, 6, s72
    v_and_b32 v250, 31, v0
    v_mfma_f32_32x32x16_bf16 v[40:55], v[192:195], v[196:199], v[40:55]
    ds_read_b128 v[176:179], v242 offset:12288
    ds_read_b128 v[180:183], v17 offset:32768
    v_lshlrev_b32 v250, 4, v250
    v_add_u32 v250, 156672, v250
    v_mfma_f32_32x32x16_bf16 v[40:55], v[204:207], v[208:211], v[40:55]
    ds_read_b128 v[184:187], v243 offset:8192
    ds_read_b128 v[188:191], v243 offset:12288
    v_add_f32 v27, v9, v9
    v_cndmask_b32 v5, 1.0, v26, s[64:65]
    v_mfma_f32_32x32x16_bf16 v[40:55], v[216:219], v[220:223], v[40:55]
    v_cndmask_b32 v6, 0, v27, s[64:65]
    v_mul_f32 v9, v28, v6
    v_mul_f32 v28, v28, v5
    v_fma_f32 v28, -v29, v6, v28
    v_mfma_f32_32x32x16_bf16 v[40:55], v[228:231], v[232:235], v[40:55]
    v_fma_f32 v29, v29, v5, v9
    v_mul_f32 v9, v26, v27
    v_mul_f32 v26, v26, v26
    v_fma_f32 v26, -v27, v27, v26
    v_dot2c_f32_bf16 v37, v192, v192
    v_dot2c_f32_bf16 v36, s94, v192
    v_dot2c_f32_bf16 v37, v193, v193
    v_dot2c_f32_bf16 v36, s94, v193
    v_dot2c_f32_bf16 v37, v194, v194
    v_dot2c_f32_bf16 v36, s94, v194
    v_dot2c_f32_bf16 v37, v195, v195
    v_dot2c_f32_bf16 v36, s94, v195
    v_dot2c_f32_bf16 v37, v204, v204
    v_dot2c_f32_bf16 v36, s94, v204
    v_dot2c_f32_bf16 v37, v205, v205
    v_dot2c_f32_bf16 v36, s94, v205
    v_dot2c_f32_bf16 v37, v206, v206
    v_dot2c_f32_bf16 v36, s94, v206
    v_dot2c_f32_bf16 v37, v207, v207
    v_dot2c_f32_bf16 v36, s94, v207
    v_dot2c_f32_bf16 v37, v216, v216
    v_dot2c_f32_bf16 v36, s94, v216
    v_dot2c_f32_bf16 v37, v217, v217
    v_dot2c_f32_bf16 v36, s94, v217
    v_dot2c_f32_bf16 v37, v218, v218
    v_dot2c_f32_bf16 v36, s94, v218
    v_dot2c_f32_bf16 v37, v219, v219
    v_dot2c_f32_bf16 v36, s94, v219
    v_dot2c_f32_bf16 v37, v228, v228
    v_dot2c_f32_bf16 v36, s94, v228
    v_dot2c_f32_bf16 v37, v229, v229
    v_dot2c_f32_bf16 v36, s94, v229
    v_dot2c_f32_bf16 v37, v230, v230
    v_dot2c_f32_bf16 v36, s94, v230
    v_dot2c_f32_bf16 v37, v231, v231
    v_dot2c_f32_bf16 v36, s94, v231
    v_dot2c_f32_bf16 v34, s94, v196
    v_dot2c_f32_bf16 v35, s94, v200
    v_dot2c_f32_bf16 v34, s94, v197
    v_dot2c_f32_bf16 v35, s94, v201
    v_dot2c_f32_bf16 v34, s94, v198
    v_dot2c_f32_bf16 v35, s94, v202
    v_dot2c_f32_bf16 v34, s94, v199
    v_dot2c_f32_bf16 v35, s94, v203
    s_waitcnt lgkmcnt(0)
    ds_read_b64_tr_b16 v[208:209], v254 offset:0
    ds_read_b64_tr_b16 v[210:211], v254 offset:2048
    ds_read_b64_tr_b16 v[212:213], v255 offset:0
    ds_read_b64_tr_b16 v[214:215], v255 offset:2048
    v_dot2c_f32_bf16 v37, v144, v144
    v_dot2c_f32_bf16 v36, s94, v144
    v_dot2c_f32_bf16 v37, v145, v145
    v_dot2c_f32_bf16 v36, s94, v145
    v_dot2c_f32_bf16 v37, v146, v146
    v_dot2c_f32_bf16 v36, s94, v146
    v_dot2c_f32_bf16 v37, v147, v147
    v_dot2c_f32_bf16 v36, s94, v147
    v_dot2c_f32_bf16 v37, v156, v156
    v_dot2c_f32_bf16 v36, s94, v156
    v_dot2c_f32_bf16 v37, v157, v157
    v_dot2c_f32_bf16 v36, s94, v157
    v_dot2c_f32_bf16 v37, v158, v158
    v_dot2c_f32_bf16 v36, s94, v158
    v_dot2c_f32_bf16 v37, v159, v159
    v_dot2c_f32_bf16 v36, s94, v159
    v_dot2c_f32_bf16 v37, v168, v168
    v_dot2c_f32_bf16 v36, s94, v168
    v_dot2c_f32_bf16 v37, v169, v169
    v_dot2c_f32_bf16 v36, s94, v169
    v_dot2c_f32_bf16 v37, v170, v170
    v_dot2c_f32_bf16 v36, s94, v170
    v_dot2c_f32_bf16 v37, v171, v171
    v_dot2c_f32_bf16 v36, s94, v171
    v_dot2c_f32_bf16 v37, v180, v180
    v_dot2c_f32_bf16 v36, s94, v180
    v_dot2c_f32_bf16 v37, v181, v181
    v_dot2c_f32_bf16 v36, s94, v181
    v_dot2c_f32_bf16 v37, v182, v182
    v_dot2c_f32_bf16 v36, s94, v182
    v_dot2c_f32_bf16 v37, v183, v183
    v_dot2c_f32_bf16 v36, s94, v183
    v_dot2c_f32_bf16 v34, s94, v148
    v_dot2c_f32_bf16 v35, s94, v152
    v_dot2c_f32_bf16 v34, s94, v149
    v_dot2c_f32_bf16 v35, s94, v153
    v_dot2c_f32_bf16 v34, s94, v150
    v_dot2c_f32_bf16 v35, s94, v154
    v_dot2c_f32_bf16 v34, s94, v151
    v_dot2c_f32_bf16 v35, s94, v155
    s_waitcnt lgkmcnt(0)
    s_barrier
    v_mfma_f32_32x32x16_bf16 v[40:55], v[144:147], v[148:151], v[40:55]
    v_mov_b32 v1, v36
    v_mov_b32 v2, v37
    s_nop 1
    v_permlane32_swap_b32 v36, v1
    v_mfma_f32_32x32x16_bf16 v[40:55], v[156:159], v[160:163], v[40:55]
    v_permlane32_swap_b32 v37, v2
    v_permlane32_swap_b32 v34, v35
    s_nop 1
    v_add_f32 v34, v34, v35
    v_mfma_f32_32x32x16_bf16 v[40:55], v[168:171], v[172:175], v[40:55]
    v_add_f32 v36, v36, v1
    v_add_f32 v37, v37, v2
    ds_write_b32 v248, v34
    v_mul_f32 v36, 0x3b124925, v36
    v_mfma_f32_32x32x16_bf16 v[40:55], v[180:183], v[184:187], v[40:55]
    v_mul_f32 v37, 0x3b124925, v37
    v_fma_f32 v37, -v36, v36, v37
    v_max_f32 v37, 0, v37
    v_cvt_pk_bf16_f32 v1, v37, v36
    v_mfma_f32_32x32x16_bf16 v[56:71], v[144:147], v[152:155], v[56:71]
    v_and_b32 v36, 0xffff0000, v1
    v_lshlrev_b32 v37, 16, v1
    v_add_f32 v37, 0x3727c5ac, v37
    v_cvt_pk_bf16_f32 v37, v37, v37
    v_mfma_f32_32x32x16_bf16 v[56:71], v[156:159], v[164:167], v[56:71]
    v_and_b32 v37, 0xffff0000, v37
    v_sqrt_f32 v37, v37
    s_nop 0
    v_cvt_pk_bf16_f32 v37, v37, v37
    v_mfma_f32_32x32x16_bf16 v[56:71], v[168:171], v[176:179], v[56:71]
    v_and_b32 v37, 0xffff0000, v37
    v_rcp_f32 v37, v37
    s_nop 0
    v_cndmask_b32 v36, v36, v37, s[68:69]
    v_mfma_f32_32x32x16_bf16 v[56:71], v[180:183], v[188:191], v[56:71]
    ds_write_b32 v249, v36
    s_setprio 0
    ds_read_b128 v[144:147], v3 offset:0
    ds_read_b128 v[148:151], v3 offset:16
    ds_read_b128 v[152:155], v3 offset:32
    ds_read_b128 v[156:159], v3 offset:48
    ds_read_b128 v[160:163], v3 offset:512
    ds_read_b128 v[164:167], v3 offset:528
    ds_read_b128 v[168:171], v3 offset:544
    ds_read_b128 v[172:175], v3 offset:560
    s_lshl_b32 s30, s4, 9
    s_add_u32 s30, s30, 158720
    v_lshl_add_u32 v2, v0, 3, s30
    v_add_u32 v3, 1792, v2
    s_mov_b64 exec, 1
    ds_add_u32 v18, v19 offset:80
    s_mov_b64 exec, -1
    s_mov_b32 s95, 0
SP_36:
    ds_read_b32 v1, v18 offset:80
    ds_read_b128 v[192:195], v250
    ds_read_b128 v[196:199], v250 offset:512
    s_waitcnt lgkmcnt(0)
    v_readfirstlane_b32 s82, v1
    s_cmp_ge_u32 s82, 4
    s_cbranch_scc1 SP_36_ok
    s_sleep 1
    s_add_u32 s95, s95, 1
    s_cmp_lt_u32 s95, 2097152
    s_cbranch_scc1 SP_36
SP_36_ok:
    v_add_f32 v192, v192, v193
    v_add_f32 v194, v194, v195
    v_add_f32 v196, v196, v197
    v_add_f32 v198, v198, v199
    v_add_f32 v34, -v192, -v194
    v_add_f32 v35, -v196, -v198
    v_fmac_f32 v40, v34, v144
    v_fmac_f32 v56, v35, v144
    v_fmac_f32 v41, v34, v145
    v_fmac_f32 v57, v35, v145
    v_fmac_f32 v42, v34, v146
    v_fmac_f32 v58, v35, v146
    v_fmac_f32 v43, v34, v147
    v_fmac_f32 v59, v35, v147
    v_fmac_f32 v44, v34, v148
    v_fmac_f32 v60, v35, v148
    v_fmac_f32 v45, v34, v149
    v_fmac_f32 v61, v35, v149
    v_fmac_f32 v46, v34, v150
    v_fmac_f32 v62, v35, v150
    v_fmac_f32 v47, v34, v151
    v_fmac_f32 v63, v35, v151
    v_fmac_f32 v48, v34, v152
    v_fmac_f32 v64, v35, v152
    v_fmac_f32 v49, v34, v153
    v_fmac_f32 v65, v35, v153
    v_fmac_f32 v50, v34, v154
    v_fmac_f32 v66, v35, v154
    v_fmac_f32 v51, v34, v155
    v_fmac_f32 v67, v35, v155
    v_fmac_f32 v52, v34, v156
    v_fmac_f32 v68, v35, v156
    v_fmac_f32 v53, v34, v157
    v_fmac_f32 v69, v35, v157
    v_fmac_f32 v54, v34, v158
    v_fmac_f32 v70, v35, v158
    v_fmac_f32 v55, v34, v159
    v_fmac_f32 v71, v35, v159
    v_mul_f32 v40, v40, v160
    v_mul_f32 v56, v56, v160
    v_mul_f32 v41, v41, v161
    v_mul_f32 v57, v57, v161
    v_mul_f32 v42, v42, v162
    v_mul_f32 v58, v58, v162
    v_mul_f32 v43, v43, v163
    v_mul_f32 v59, v59, v163
    v_mul_f32 v44, v44, v164
    v_mul_f32 v60, v60, v164
    v_mul_f32 v45, v45, v165
    v_mul_f32 v61, v61, v165
    v_mul_f32 v46, v46, v166
    v_mul_f32 v62, v62, v166
    v_mul_f32 v47, v47, v167
    v_mul_f32 v63, v63, v167
    v_mul_f32 v48, v48, v168
    v_mul_f32 v64, v64, v168
    v_mul_f32 v49, v49, v169
    v_mul_f32 v65, v65, v169
    v_mul_f32 v50, v50, v170
    v_mul_f32 v66, v66, v170
    v_mul_f32 v51, v51, v171
    v_mul_f32 v67, v67, v171
    v_mul_f32 v52, v52, v172
    v_mul_f32 v68, v68, v172
    v_mul_f32 v53, v53, v173
    v_mul_f32 v69, v69, v173
    v_mul_f32 v54, v54, v174
    v_mul_f32 v70, v70, v174
    v_mul_f32 v55, v55, v175
    v_mul_f32 v71, v71, v175
    v_fmac_f32 v41, v22, v40
    v_fmac_f32 v57, v22, v56
    v_fmac_f32 v41, v33, v56
    v_fmac_f32 v57, v23, v40
    v_fmac_f32 v42, v22, v41
    v_fmac_f32 v58, v22, v57
    v_fmac_f32 v42, v33, v57
    v_fmac_f32 v58, v23, v41
    v_fmac_f32 v43, v22, v42
    v_fmac_f32 v59, v22, v58
    v_fmac_f32 v43, v33, v58
    v_fmac_f32 v59, v23, v42
    v_fmac_f32 v44, v22, v43
    v_fmac_f32 v60, v22, v59
    v_fmac_f32 v44, v33, v59
    v_fmac_f32 v60, v23, v43
    v_fmac_f32 v45, v22, v44
    v_fmac_f32 v61, v22, v60
    v_fmac_f32 v45, v33, v60
    v_fmac_f32 v61, v23, v44
    v_fmac_f32 v46, v22, v45
    v_fmac_f32 v62, v22, v61
    v_fmac_f32 v46, v33, v61
    v_fmac_f32 v62, v23, v45
    v_fmac_f32 v47, v22, v46
    v_fmac_f32 v63, v22, v62
    v_fmac_f32 v47, v33, v62
    v_fmac_f32 v63, v23, v46
    v_fmac_f32 v48, v22, v47
    v_fmac_f32 v64, v22, v63
    v_fmac_f32 v48, v33, v63
    v_fmac_f32 v64, v23, v47
    v_fmac_f32 v49, v22, v48
    v_fmac_f32 v65, v22, v64
    v_fmac_f32 v49, v33, v64
    v_fmac_f32 v65, v23, v48
    v_fmac_f32 v50, v22, v49
    v_fmac_f32 v66, v22, v65
    v_fmac_f32 v50, v33, v65
    v_fmac_f32 v66, v23, v49
    v_fmac_f32 v51, v22, v50
    v_fmac_f32 v67, v22, v66
    v_fmac_f32 v51, v33, v66
    v_fmac_f32 v67, v23, v50
    v_fmac_f32 v52, v22, v51
    v_fmac_f32 v68, v22, v67
    v_fmac_f32 v52, v33, v67
    v_fmac_f32 v68, v23, v51
    v_fmac_f32 v53, v22, v52
    v_fmac_f32 v69, v22, v68
    v_fmac_f32 v53, v33, v68
    v_fmac_f32 v69, v23, v52
    v_fmac_f32 v54, v22, v53
    v_fmac_f32 v70, v22, v69
    v_fmac_f32 v54, v33, v69
    v_fmac_f32 v70, v23, v53
    v_fmac_f32 v55, v22, v54
    v_fmac_f32 v71, v22, v70
    v_fmac_f32 v55, v33, v70
    v_fmac_f32 v71, v23, v54
    ds_write2_b32 v3, v55, v71 offset1:1
    s_mov_b64 exec, 1
    ds_add_u32 v18, v19 offset:80
    s_mov_b64 exec, -1
    s_mov_b32 s95, 0
SP_37:
    ds_read_b32 v1, v18 offset:80
    ds_read_b64 v[192:193], v2 offset:0
    ds_read_b64 v[194:195], v2 offset:256
    ds_read_b64 v[196:197], v2 offset:512
    ds_read_b64 v[198:199], v2 offset:768
    ds_read_b64 v[200:201], v2 offset:1024
    ds_read_b64 v[202:203], v2 offset:1280
    ds_read_b64 v[204:205], v2 offset:1536
    s_waitcnt lgkmcnt(0)
    v_readfirstlane_b32 s82, v1
    s_cmp_ge_u32 s82, 8
    s_cbranch_scc1 SP_37_ok
    s_sleep 1
    s_add_u32 s95, s95, 1
    s_cmp_lt_u32 s95, 2097152
    s_cbranch_scc1 SP_37
SP_37_ok:
    v_fma_f32 v194, v24, v192, v194
    v_fma_f32 v195, v24, v193, v195
    v_fma_f32 v194, -v25, v193, v194
    v_fma_f32 v195, v25, v192, v195
    v_fma_f32 v196, v24, v194, v196
    v_fma_f32 v197, v24, v195, v197
    v_fma_f32 v196, -v25, v195, v196
    v_fma_f32 v197, v25, v194, v197
    v_fma_f32 v198, v24, v196, v198
    v_fma_f32 v199, v24, v197, v199
    v_fma_f32 v198, -v25, v197, v198
    v_fma_f32 v199, v25, v196, v199
    v_fma_f32 v200, v24, v198, v200
    v_fma_f32 v201, v24, v199, v201
    v_fma_f32 v200, -v25, v199, v200
    v_fma_f32 v201, v25, v198, v201
    v_fma_f32 v202, v24, v200, v202
    v_fma_f32 v203, v24, v201, v203
    v_fma_f32 v202, -v25, v201, v202
    v_fma_f32 v203, v25, v200, v203
    v_fma_f32 v38, v24, v202, v204
    v_fma_f32 v39, v24, v203, v205
    v_fma_f32 v38, -v25, v203, v38
    v_fma_f32 v39, v25, v202, v39
    s_cmp_lg_u32 s4, 3
    s_cbranch_scc1 K_nopub
    v_fma_f32 v192, v24, v38, v55
    v_fma_f32 v194, v24, v39, v71
    v_fma_f32 v192, -v25, v39, v192
    v_fma_f32 v194, v25, v38, v194
    v_mov_b32 v193, s84
    v_mov_b32 v195, s84
    s_lshl_b32 s30, s6, 4
    s_add_u32 s30, s30, s5
    s_lshl_b32 s30, s30, 9
    s_add_u32 s30, s30, 18349568
    v_lshlrev_b32 v1, 4, v0
    s_mov_b32 exec_lo, 0
    buffer_store_dwordx4 v[192:195], v1, s[20:23], s30 offen sc1
    s_mov_b32 exec_lo, -1
K_nopub:
    s_mul_i32 s76, s5, 229376
    s_lshl_b32 s30, s6, 13
    s_add_u32 s76, s76, s30
    s_lshl_b32 s30, s4, 10
    s_add_u32 s76, s76, s30
    s_add_u32 s76, s76, 0
    s_add_u32 s77, s76, 114688
    v_add_f32 v27, v9, v9
    v_cndmask_b32 v5, 1.0, v26, s[66:67]
    v_cndmask_b32 v6, 0, v27, s[66:67]
    v_mul_f32 v9, v28, v6
    v_mul_f32 v28, v28, v5
    v_fma_f32 v28, -v29, v6, v28
    v_fma_f32 v29, v29, v5, v9
    v_mul_f32 v9, v26, v27
    v_mul_f32 v26, v26, v26
    v_fma_f32 v26, -v27, v27, v26
    v_add_f32 v27, v9, v9
    v_mul_f32 v9, v26, v27
    v_mul_f32 v136, v26, v26
    v_fma_f32 v136, -v27, v27, v136
    v_add_f32 v137, v9, v9
    v_mul_f32 v104, v22, v30
    v_mul_f32 v120, v22, v31
    v_fmac_f32 v104, v33, v31
    v_fmac_f32 v120, v23, v30
    v_mul_f32 v105, v22, v104
    v_mul_f32 v121, v22, v120
    v_fmac_f32 v105, v33, v120
    v_fmac_f32 v121, v23, v104
    v_mul_f32 v106, v22, v105
    v_mul_f32 v122, v22, v121
    v_fmac_f32 v106, v33, v121
    v_fmac_f32 v122, v23, v105
    v_mul_f32 v107, v22, v106
    v_mul_f32 v123, v22, v122
    v_fmac_f32 v107, v33, v122
    v_fmac_f32 v123, v23, v106
    v_mul_f32 v108, v22, v107
    v_mul_f32 v124, v22, v123
    v_fmac_f32 v108, v33, v123
    v_fmac_f32 v124, v23, v107
    v_mul_f32 v109, v22, v108
    v_mul_f32 v125, v22, v124
    v_fmac_f32 v109, v33, v124
    v_fmac_f32 v125, v23, v108
    v_mul_f32 v110, v22, v109
    v_mul_f32 v126, v22, v125
    v_fmac_f32 v110, v33, v125
    v_fmac_f32 v126, v23, v109
    v_mul_f32 v111, v22, v110
    v_mul_f32 v127, v22, v126
    v_fmac_f32 v111, v33, v126
    v_fmac_f32 v127, v23, v110
    v_mul_f32 v112, v22, v111
    v_mul_f32 v128, v22, v127
    v_fmac_f32 v112, v33, v127
    v_fmac_f32 v128, v23, v111
    v_mul_f32 v113, v22, v112
    v_mul_f32 v129, v22, v128
    v_fmac_f32 v113, v33, v128
    v_fmac_f32 v129, v23, v112
    v_mul_f32 v114, v22, v113
    v_mul_f32 v130, v22, v129
    v_fmac_f32 v114, v33, v129
    v_fmac_f32 v130, v23, v113
    v_mul_f32 v115, v22, v114
    v_mul_f32 v131, v22, v130
    v_fmac_f32 v115, v33, v130
    v_fmac_f32 v131, v23, v114
    v_mul_f32 v116, v22, v115
    v_mul_f32 v132, v22, v131
    v_fmac_f32 v116, v33, v131
    v_fmac_f32 v132, v23, v115
    v_mul_f32 v117, v22, v116
    v_mul_f32 v133, v22, v132
    v_fmac_f32 v117, v33, v132
    v_fmac_f32 v133, v23, v116
    v_mul_f32 v118, v22, v117
    v_mul_f32 v134, v22, v133
    v_fmac_f32 v118, v33, v133
    v_fmac_f32 v134, v23, v117
    v_mul_f32 v119, v22, v118
    v_mul_f32 v135, v22, v134
    v_fmac_f32 v119, v33, v134
    v_fmac_f32 v135, v23, v118
    v_xor_b32 v31, 0x80000000, v31
    v_xor_b32 v32, 0x80000000, v30
    v_mul_f32 v144, v30, v40
    v_mul_f32 v160, v32, v56
    v_fmac_f32 v144, v31, v56
    v_fmac_f32 v160, v31, v40
    v_mul_f32 v145, v30, v41
    v_mul_f32 v161, v32, v57
    v_fmac_f32 v145, v31, v57
    v_fmac_f32 v161, v31, v41
    v_mul_f32 v146, v30, v42
    v_mul_f32 v162, v32, v58
    v_fmac_f32 v146, v31, v58
    v_fmac_f32 v162, v31, v42
    v_mul_f32 v147, v30, v43
    v_mul_f32 v163, v32, v59
    v_fmac_f32 v147, v31, v59
    v_fmac_f32 v163, v31, v43
    v_mul_f32 v148, v30, v44
    v_mul_f32 v164, v32, v60
    v_fmac_f32 v148, v31, v60
    v_fmac_f32 v164, v31, v44
    v_mul_f32 v149, v30, v45
    v_mul_f32 v165, v32, v61
    v_fmac_f32 v149, v31, v61
    v_fmac_f32 v165, v31, v45
    v_mul_f32 v150, v30, v46
    v_mul_f32 v166, v32, v62
    v_fmac_f32 v150, v31, v62
    v_fmac_f32 v166, v31, v46
    v_mul_f32 v151, v30, v47
    v_mul_f32 v167, v32, v63
    v_fmac_f32 v151, v31, v63
    v_fmac_f32 v167, v31, v47
    v_mul_f32 v152, v30, v48
    v_mul_f32 v168, v32, v64
    v_fmac_f32 v152, v31, v64
    v_fmac_f32 v168, v31, v48
    v_mul_f32 v153, v30, v49
    v_mul_f32 v169, v32, v65
    v_fmac_f32 v153, v31, v65
    v_fmac_f32 v169, v31, v49
    v_mul_f32 v154, v30, v50
    v_mul_f32 v170, v32, v66
    v_fmac_f32 v154, v31, v66
    v_fmac_f32 v170, v31, v50
    v_mul_f32 v155, v30, v51
    v_mul_f32 v171, v32, v67
    v_fmac_f32 v155, v31, v67
    v_fmac_f32 v171, v31, v51
    v_mul_f32 v156, v30, v52
    v_mul_f32 v172, v32, v68
    v_fmac_f32 v156, v31, v68
    v_fmac_f32 v172, v31, v52
    v_mul_f32 v157, v30, v53
    v_mul_f32 v173, v32, v69
    v_fmac_f32 v157, v31, v69
    v_fmac_f32 v173, v31, v53
    v_mul_f32 v158, v30, v54
    v_mul_f32 v174, v32, v70
    v_fmac_f32 v158, v31, v70
    v_fmac_f32 v174, v31, v54
    v_mul_f32 v159, v30, v55
    v_mul_f32 v175, v32, v71
    v_fmac_f32 v159, v31, v71
    v_fmac_f32 v175, v31, v55
    v_mov_b32 v40, 0
    v_mov_b32 v41, s84
    v_mov_b32 v42, 0
    v_mov_b32 v43, s84
    s_cmp_ge_u32 s5, 14
    s_cbranch_scc1 K_agi
    v_mov_b32 v44, 0
    v_mov_b32 v45, s84
    v_mov_b32 v46, 0
    v_mov_b32 v47, s84
    s_cmp_ge_u32 s5, 12
    s_cbranch_scc1 K_agi
    v_mov_b32 v48, 0
    v_mov_b32 v49, s84
    v_mov_b32 v50, 0
    v_mov_b32 v51, s84
    s_cmp_ge_u32 s5, 10
    s_cbranch_scc1 K_agi
    v_mov_b32 v52, 0
    v_mov_b32 v53, s84
    v_mov_b32 v54, 0
    v_mov_b32 v55, s84
    s_cmp_ge_u32 s5, 8
    s_cbranch_scc1 K_agi
    v_mov_b32 v56, 0
    v_mov_b32 v57, s84
    v_mov_b32 v58, 0
    v_mov_b32 v59, s84
    s_cmp_ge_u32 s5, 6
    s_cbranch_scc1 K_agi
    v_mov_b32 v60, 0
    v_mov_b32 v61, s84
    v_mov_b32 v62, 0
    v_mov_b32 v63, s84
    s_cmp_ge_u32 s5, 4
    s_cbranch_scc1 K_agi
    v_mov_b32 v64, 0
    v_mov_b32 v65, s84
    v_mov_b32 v66, 0
    v_mov_b32 v67, s84
    s_cmp_ge_u32 s5, 2
    s_cbranch_scc1 K_agi
    v_mov_b32 v68, 0
    v_mov_b32 v69, s84
    v_mov_b32 v70, 0
    v_mov_b32 v71, s84
K_agi:
    s_lshl_b32 s90, s6, 11
    s_lshl_b32 s30, s4, 8
    s_add_u32 s90, s90, s30
    s_add_u32 s90, s90, 18464768
    v_and_b32 v34, 31, v0
    v_lshlrev_b32 v34, 3, v34
    v_lshl_add_u32 v34, v21, 10, v34
    v_min_u32 v35, 6, v0
    v_lshlrev_b32 v35, 7, v35
    buffer_load_dwordx2 v[8:9], v34, s[20:23], s90 offen sc1
    buffer_load_dwordx2 v[140:141], v35, s[20:23], s75 offen sc1
    s_lshl_b32 s30, s91, 7
    s_add_u32 s30, s30, s78
    v_mul_u32_u24 v1, 32768, v21
    s_mov_b32 exec_lo, 1
    s_mov_b32 exec_hi, 1
    buffer_load_dword v251, v1, s[20:23], s30 offen sc1
    s_mov_b64 exec, -1
    s_lshl_b32 s92, s6, 4
    s_add_u32 s92, s92, s5
    s_lshl_b32 s92, s92, 9
    s_add_u32 s92, s92, 18341888
    s_add_u32 s93, s92, 4096
    v_lshlrev_b32 v3, 4, v0
    s_lshl_b32 s29, s85, 6
    s_and_b32 s31, s4, 1
    s_lshl_b32 s31, s31, 5
    s_add_u32 s29, s29, s31
    s_lshl_b32 s29, s29, 2
    s_add_u32 s29, s29, 155648
    v_lshl_add_u32 v4, v21, 4, s29
    v_and_b32 v5, 16, v0
    v_lshl_add_u32 v4, v5, 2, v4
    ds_read_b128 v[192:195], v4 offset:0
    ds_read_b128 v[200:203], v4 offset:512
    ds_read_b128 v[196:199], v4 offset:32
    ds_read_b128 v[204:207], v4 offset:544
    v_lshlrev_b32 v176, 16, v208
    v_and_b32 v177, 0xffff0000, v208
    v_lshlrev_b32 v178, 16, v209
    v_and_b32 v179, 0xffff0000, v209
    v_lshlrev_b32 v180, 16, v210
    v_and_b32 v181, 0xffff0000, v210
    v_lshlrev_b32 v182, 16, v211
    v_and_b32 v183, 0xffff0000, v211
    v_lshlrev_b32 v184, 16, v212
    v_and_b32 v185, 0xffff0000, v212
    v_lshlrev_b32 v186, 16, v213
    v_and_b32 v187, 0xffff0000, v213
    v_lshlrev_b32 v188, 16, v214
    v_and_b32 v189, 0xffff0000, v214
    v_lshlrev_b32 v190, 16, v215
    v_and_b32 v191, 0xffff0000, v215
    s_waitcnt lgkmcnt(0)
    v_sub_f32 v176, v176, v192
    v_sub_f32 v177, v177, v193
    v_sub_f32 v178, v178, v194
    v_sub_f32 v179, v179, v195
    v_sub_f32 v180, v180, v196
    v_sub_f32 v181, v181, v197
    v_sub_f32 v182, v182, v198
    v_sub_f32 v183, v183, v199
    v_sub_f32 v184, v184, v192
    v_sub_f32 v185, v185, v193
    v_sub_f32 v186, v186, v194
    v_sub_f32 v187, v187, v195
    v_sub_f32 v188, v188, v196
    v_sub_f32 v189, v189, v197
    v_sub_f32 v190, v190, v198
    v_sub_f32 v191, v191, v199
    v_cvt_pk_bf16_f32 v176, v176, v177
    v_cvt_pk_bf16_f32 v178, v178, v179
    v_cvt_pk_bf16_f32 v180, v180, v181
    v_cvt_pk_bf16_f32 v182, v182, v183
    v_cvt_pk_bf16_f32 v184, v184, v185
    v_cvt_pk_bf16_f32 v186, v186, v187
    v_cvt_pk_bf16_f32 v188, v188, v189
    v_cvt_pk_bf16_f32 v190, v190, v191
    v_and_b32 v177, 0xffff0000, v176
    v_lshlrev_b32 v176, 16, v176
    v_and_b32 v179, 0xffff0000, v178
    v_lshlrev_b32 v178, 16, v178
    v_and_b32 v181, 0xffff0000, v180
    v_lshlrev_b32 v180, 16, v180
    v_and_b32 v183, 0xffff0000, v182
    v_lshlrev_b32 v182, 16, v182
    v_and_b32 v185, 0xffff0000, v184
    v_lshlrev_b32 v184, 16, v184
    v_and_b32 v187, 0xffff0000, v186
    v_lshlrev_b32 v186, 16, v186
    v_and_b32 v189, 0xffff0000, v188
    s_cmp_lt_u32 s5, 15
    s_cbranch_scc1 AL_38
    s_cmp_ge_u32 s5, 16
    s_cselect_b32 exec_lo, -1, 0
    buffer_load_dwordx4 v[40:43], v3, s[20:23], s92 offen offset:0
AL_38:
    s_cmp_lt_u32 s5, 13
    s_cbranch_scc1 AL_39
    s_cmp_ge_u32 s5, 14
    s_cselect_b32 exec_lo, -1, 0
    buffer_load_dwordx4 v[44:47], v3, s[20:23], s92 offen offset:1024
AL_39:
    s_cmp_lt_u32 s5, 11
    s_cbranch_scc1 AL_40
    s_cmp_ge_u32 s5, 12
    s_cselect_b32 exec_lo, -1, 0
    buffer_load_dwordx4 v[48:51], v3, s[20:23], s92 offen offset:2048
AL_40:
    s_cmp_lt_u32 s5, 9
    s_cbranch_scc1 AL_41
    s_cmp_ge_u32 s5, 10
    s_cselect_b32 exec_lo, -1, 0
    buffer_load_dwordx4 v[52:55], v3, s[20:23], s92 offen offset:3072
AL_41:
    s_cmp_lt_u32 s5, 7
    s_cbranch_scc1 AL_42
    s_cmp_ge_u32 s5, 8
    s_cselect_b32 exec_lo, -1, 0
    buffer_load_dwordx4 v[56:59], v3, s[20:23], s93 offen offset:0
AL_42:
    s_cmp_lt_u32 s5, 5
    s_cbranch_scc1 AL_43
    s_cmp_ge_u32 s5, 6
    s_cselect_b32 exec_lo, -1, 0
    buffer_load_dwordx4 v[60:63], v3, s[20:23], s93 offen offset:1024
AL_43:
    s_cmp_lt_u32 s5, 3
    s_cbranch_scc1 AL_44
    s_cmp_ge_u32 s5, 4
    s_cselect_b32 exec_lo, -1, 0
    buffer_load_dwordx4 v[64:67], v3, s[20:23], s93 offen offset:2048
AL_44:
    s_cmp_lt_u32 s5, 1
    s_cbranch_scc1 AL_45
    s_cmp_ge_u32 s5, 2
    s_cselect_b32 exec_lo, -1, 0
    buffer_load_dwordx4 v[68:71], v3, s[20:23], s93 offen offset:3072
AL_45:
    s_mov_b32 exec_lo, -1
    v_lshlrev_b32 v188, 16, v188
    v_and_b32 v191, 0xffff0000, v190
    v_lshlrev_b32 v190, 16, v190
    v_mul_f32 v176, v176, v200
    v_mul_f32 v177, v177, v201
    v_mul_f32 v178, v178, v202
    v_mul_f32 v179, v179, v203
    v_mul_f32 v180, v180, v204
    v_mul_f32 v181, v181, v205
    v_mul_f32 v182, v182, v206
    v_mul_f32 v183, v183, v207
    v_mul_f32 v184, v184, v200
    v_mul_f32 v185, v185, v201
    v_mul_f32 v186, v186, v202
    v_mul_f32 v187, v187, v203
    v_mul_f32 v188, v188, v204
    v_mul_f32 v189, v189, v205
    v_mul_f32 v190, v190, v206
    v_mul_f32 v191, v191, v207
    v_cvt_pk_bf16_f32 v176, v176, v177
    v_cvt_pk_bf16_f32 v178, v178, v179
    v_cvt_pk_bf16_f32 v180, v180, v181
    v_cvt_pk_bf16_f32 v182, v182, v183
    v_cvt_pk_bf16_f32 v184, v184, v185
    v_cvt_pk_bf16_f32 v186, v186, v187
    v_cvt_pk_bf16_f32 v188, v188, v189
    v_cvt_pk_bf16_f32 v190, v190, v191
    v_and_b32 v177, 0xffff0000, v176
    v_lshlrev_b32 v176, 16, v176
    v_and_b32 v179, 0xffff0000, v178
    v_lshlrev_b32 v178, 16, v178
    v_and_b32 v181, 0xffff0000, v180
    v_lshlrev_b32 v180, 16, v180
    v_and_b32 v183, 0xffff0000, v182
    v_lshlrev_b32 v182, 16, v182
    v_and_b32 v185, 0xffff0000, v184
    v_lshlrev_b32 v184, 16, v184
    v_and_b32 v187, 0xffff0000, v186
    v_lshlrev_b32 v186, 16, v186
    v_and_b32 v189, 0xffff0000, v188
    v_lshlrev_b32 v188, 16, v188
    v_and_b32 v191, 0xffff0000, v190
    v_lshlrev_b32 v190, 16, v190
    v_mul_f32 v176, v176, v142
    v_mul_f32 v177, v177, v142
    v_mul_f32 v178, v178, v142
    v_mul_f32 v179, v179, v142
    v_mul_f32 v180, v180, v142
    v_mul_f32 v181, v181, v142
    v_mul_f32 v182, v182, v142
    v_mul_f32 v183, v183, v142
    v_mul_f32 v184, v184, v139
    v_mul_f32 v185, v185, v139
    v_mul_f32 v186, v186, v139
    v_mul_f32 v187, v187, v139
    v_mul_f32 v188, v188, v139
    v_mul_f32 v189, v189, v139
    v_mul_f32 v190, v190, v139
    v_mul_f32 v191, v191, v139
    v_cvt_pk_bf16_f32 v216, v176, v177
    v_cvt_pk_bf16_f32 v217, v178, v179
    v_cvt_pk_bf16_f32 v218, v180, v181
    v_cvt_pk_bf16_f32 v219, v182, v183
    v_cvt_pk_bf16_f32 v220, v184, v185
    v_cvt_pk_bf16_f32 v221, v186, v187
    v_cvt_pk_bf16_f32 v222, v188, v189
    v_cvt_pk_bf16_f32 v223, v190, v191
    s_waitcnt vmcnt(0)
    s_mov_b32 s95, 0
K_horner:
    v_min3_u32 v1, s84, v41, v43
    v_max3_u32 v2, s84, v41, v43
    v_fma_f32 v4, v136, v40, v44
    v_fma_f32 v5, v136, v42, v46
    v_fma_f32 v4, -v137, v42, v4
    v_fma_f32 v5, v137, v40, v5
    v_min3_u32 v1, v1, v45, v47
    v_max3_u32 v2, v2, v45, v47
    v_fma_f32 v6, v136, v4, v48
    v_fma_f32 v7, v136, v5, v50
    v_fma_f32 v6, -v137, v5, v6
    v_fma_f32 v7, v137, v4, v7
    v_min3_u32 v1, v1, v49, v51
    v_max3_u32 v2, v2, v49, v51
    v_fma_f32 v4, v136, v6, v52
    v_fma_f32 v5, v136, v7, v54
    v_fma_f32 v4, -v137, v7, v4
    v_fma_f32 v5, v137, v6, v5
    v_min3_u32 v1, v1, v53, v55
    v_max3_u32 v2, v2, v53, v55
    v_fma_f32 v6, v136, v4, v56
    v_fma_f32 v7, v136, v5, v58
    v_fma_f32 v6, -v137, v5, v6
    v_fma_f32 v7, v137, v4, v7
    v_min3_u32 v1, v1, v57, v59
    v_max3_u32 v2, v2, v57, v59
    v_fma_f32 v4, v136, v6, v60
    v_fma_f32 v5, v136, v7, v62
    v_fma_f32 v4, -v137, v7, v4
    v_fma_f32 v5, v137, v6, v5
    v_min3_u32 v1, v1, v61, v63
    v_max3_u32 v2, v2, v61, v63
    v_fma_f32 v6, v136, v4, v64
    v_fma_f32 v7, v136, v5, v66
    v_fma_f32 v6, -v137, v5, v6
    v_fma_f32 v7, v137, v4, v7
    v_min3_u32 v1, v1, v65, v67
    v_max3_u32 v2, v2, v65, v67
    v_fma_f32 v4, v136, v6, v68
    v_fma_f32 v5, v136, v7, v70
    v_fma_f32 v4, -v137, v7, v4
    v_fma_f32 v5, v137, v6, v5
    v_min3_u32 v1, v1, v69, v71
    v_max3_u32 v2, v2, v69, v71
    v_cmp_eq_u32 vcc, v1, v2
    v_mov_b32 v6, v4
    v_mov_b32 v7, v5
    s_cmp_eq_u64 vcc, -1
    s_cbranch_scc1 K_hok
    s_add_u32 s95, s95, 1
    s_cmp_ge_u32 s95, 2097152
    s_cbranch_scc1 K_hok
    s_lshl_b32 s30, s6, 13
    s_add_u32 s30, s30, 18350588
    s_sub_u32 s31, s5, 1
    v_min_u32 v1, s31, v0
    v_lshlrev_b32 v1, 9, v1
    s_mov_b64 exec, 0xffff
K_lp:
    s_sleep 2
    buffer_load_dword v2, v1, s[20:23], s30 offen sc1
    s_add_u32 s95, s95, 1
    s_waitcnt vmcnt(0)
    v_cmp_eq_u32 vcc, s84, v2
    s_cmp_ge_u32 s95, 2097152
    s_cbranch_scc1 K_lpx
    s_cmp_eq_u64 vcc, exec
    s_cbranch_scc0 K_lp
K_lpx:
    s_mov_b64 exec, -1
    s_cmp_lt_u32 s5, 15
    s_cbranch_scc1 AL_46
    s_cmp_ge_u32 s5, 16
    s_cselect_b32 exec_lo, -1, 0
    buffer_load_dwordx4 v[40:43], v3, s[20:23], s92 offen offset:0 sc1
AL_46:
    s_cmp_lt_u32 s5, 13
    s_cbranch_scc1 AL_47
    s_cmp_ge_u32 s5, 14
    s_cselect_b32 exec_lo, -1, 0
    buffer_load_dwordx4 v[44:47], v3, s[20:23], s92 offen offset:1024 sc1
AL_47:
    s_cmp_lt_u32 s5, 11
    s_cbranch_scc1 AL_48
    s_cmp_ge_u32 s5, 12
    s_cselect_b32 exec_lo, -1, 0
    buffer_load_dwordx4 v[48:51], v3, s[20:23], s92 offen offset:2048 sc1
AL_48:
    s_cmp_lt_u32 s5, 9
    s_cbranch_scc1 AL_49
    s_cmp_ge_u32 s5, 10
    s_cselect_b32 exec_lo, -1, 0
    buffer_load_dwordx4 v[52:55], v3, s[20:23], s92 offen offset:3072 sc1
AL_49:
    s_cmp_lt_u32 s5, 7
    s_cbranch_scc1 AL_50
    s_cmp_ge_u32 s5, 8
    s_cselect_b32 exec_lo, -1, 0
    buffer_load_dwordx4 v[56:59], v3, s[20:23], s93 offen offset:0 sc1
AL_50:
    s_cmp_lt_u32 s5, 5
    s_cbranch_scc1 AL_51
    s_cmp_ge_u32 s5, 6
    s_cselect_b32 exec_lo, -1, 0
    buffer_load_dwordx4 v[60:63], v3, s[20:23], s93 offen offset:1024 sc1
AL_51:
    s_cmp_lt_u32 s5, 3
    s_cbranch_scc1 AL_52
    s_cmp_ge_u32 s5, 4
    s_cselect_b32 exec_lo, -1, 0
    buffer_load_dwordx4 v[64:67], v3, s[20:23], s93 offen offset:2048 sc1
AL_52:
    s_cmp_lt_u32 s5, 1
    s_cbranch_scc1 AL_53
    s_cmp_ge_u32 s5, 2
    s_cselect_b32 exec_lo, -1, 0
    buffer_load_dwordx4 v[68:71], v3, s[20:23], s93 offen offset:3072 sc1
AL_53:
    s_mov_b32 exec_lo, -1
    s_waitcnt vmcnt(0)
    s_branch K_horner
K_hok:
    v_permlane32_swap_b32 v4, v6
    v_permlane32_swap_b32 v5, v7
    s_nop 0
    v_fma_f32 v6, v26, v4, v6
    v_fma_f32 v7, v26, v5, v7
    v_fma_f32 v6, -v27, v5, v6
    v_fma_f32 v7, v27, v4, v7
    v_fma_f32 v38, v28, v6, v38
    v_fma_f32 v39, v28, v7, v39
    v_fma_f32 v38, -v29, v7, v38
    v_fma_f32 v39, v29, v6, v39
    v_xor_b32 v36, 0x80000000, v38
    v_xor_b32 v37, 0x80000000, v39
    v_fmac_f32 v144, v38, v104
    v_fmac_f32 v160, v37, v104
    v_fmac_f32 v144, v37, v120
    v_fmac_f32 v160, v36, v120
    v_fmac_f32 v145, v38, v105
    v_fmac_f32 v161, v37, v105
    v_fmac_f32 v145, v37, v121
    v_fmac_f32 v161, v36, v121
    v_cvt_pk_bf16_f32 v40, v144, v145
    v_cvt_pk_bf16_f32 v48, v160, v161
    v_fmac_f32 v146, v38, v106
    v_fmac_f32 v162, v37, v106
    v_fmac_f32 v146, v37, v122
    v_fmac_f32 v162, v36, v122
    v_fmac_f32 v147, v38, v107
    v_fmac_f32 v163, v37, v107
    v_fmac_f32 v147, v37, v123
    v_fmac_f32 v163, v36, v123
    v_cvt_pk_bf16_f32 v41, v146, v147
    v_cvt_pk_bf16_f32 v49, v162, v163
    v_fmac_f32 v148, v38, v108
    v_fmac_f32 v164, v37, v108
    v_fmac_f32 v148, v37, v124
    v_fmac_f32 v164, v36, v124
    v_fmac_f32 v149, v38, v109
    v_fmac_f32 v165, v37, v109
    v_fmac_f32 v149, v37, v125
    v_fmac_f32 v165, v36, v125
    v_cvt_pk_bf16_f32 v42, v148, v149
    v_cvt_pk_bf16_f32 v50, v164, v165
    v_fmac_f32 v150, v38, v110
    v_fmac_f32 v166, v37, v110
    v_fmac_f32 v150, v37, v126
    v_fmac_f32 v166, v36, v126
    v_fmac_f32 v151, v38, v111
    v_fmac_f32 v167, v37, v111
    v_fmac_f32 v151, v37, v127
    v_fmac_f32 v167, v36, v127
    v_cvt_pk_bf16_f32 v43, v150, v151
    v_cvt_pk_bf16_f32 v51, v166, v167
    v_fmac_f32 v152, v38, v112
    v_fmac_f32 v168, v37, v112
    v_fmac_f32 v152, v37, v128
    v_fmac_f32 v168, v36, v128
    v_fmac_f32 v153, v38, v113
    v_fmac_f32 v169, v37, v113
    v_fmac_f32 v153, v37, v129
    v_fmac_f32 v169, v36, v129
    v_cvt_pk_bf16_f32 v44, v152, v153
    v_cvt_pk_bf16_f32 v52, v168, v169
    v_fmac_f32 v154, v38, v114
    v_fmac_f32 v170, v37, v114
    v_fmac_f32 v154, v37, v130
    v_fmac_f32 v170, v36, v130
    v_fmac_f32 v155, v38, v115
    v_fmac_f32 v171, v37, v115
    v_fmac_f32 v155, v37, v131
    v_fmac_f32 v171, v36, v131
    v_cvt_pk_bf16_f32 v45, v154, v155
    v_cvt_pk_bf16_f32 v53, v170, v171
    v_fmac_f32 v156, v38, v116
    v_fmac_f32 v172, v37, v116
    v_fmac_f32 v156, v37, v132
    v_fmac_f32 v172, v36, v132
    v_fmac_f32 v157, v38, v117
    v_fmac_f32 v173, v37, v117
    v_fmac_f32 v157, v37, v133
    v_fmac_f32 v173, v36, v133
    v_cvt_pk_bf16_f32 v46, v156, v157
    v_cvt_pk_bf16_f32 v54, v172, v173
    v_fmac_f32 v158, v38, v118
    v_fmac_f32 v174, v37, v118
    v_fmac_f32 v158, v37, v134
    v_fmac_f32 v174, v36, v134
    v_fmac_f32 v159, v38, v119
    v_fmac_f32 v175, v37, v119
    v_fmac_f32 v159, v37, v135
    v_fmac_f32 v175, v36, v135
    v_cvt_pk_bf16_f32 v47, v158, v159
    v_cvt_pk_bf16_f32 v55, v174, v175
    s_setprio 3
    v_mfma_f32_32x32x16_bf16 v[104:119], v[40:43], v[72:75], 0
    v_mfma_f32_32x32x16_bf16 v[120:135], v[48:51], v[72:75], 0
    v_mfma_f32_32x32x16_bf16 v[104:119], v[44:47], v[76:79], v[104:119]
    v_mfma_f32_32x32x16_bf16 v[120:135], v[52:55], v[76:79], v[120:135]
    s_setprio 0
    s_add_u32 s30, s76, 4096
    s_add_u32 s31, s77, 4096
    s_nop 7
    v_cvt_pk_bf16_f32 v56, v104, v105
    v_cvt_pk_bf16_f32 v57, v106, v107
    v_cvt_pk_bf16_f32 v58, v108, v109
    v_cvt_pk_bf16_f32 v59, v110, v111
    v_cvt_pk_bf16_f32 v60, v112, v113
    v_cvt_pk_bf16_f32 v61, v114, v115
    v_cvt_pk_bf16_f32 v62, v116, v117
    v_cvt_pk_bf16_f32 v63, v118, v119
    v_cvt_pk_bf16_f32 v64, v120, v121
    v_cvt_pk_bf16_f32 v65, v122, v123
    v_cvt_pk_bf16_f32 v66, v124, v125
    v_cvt_pk_bf16_f32 v67, v126, v127
    v_cvt_pk_bf16_f32 v68, v128, v129
    v_cvt_pk_bf16_f32 v69, v130, v131
    v_cvt_pk_bf16_f32 v70, v132, v133
    v_cvt_pk_bf16_f32 v71, v134, v135
    s_add_u32 s30, s76, 4096
    s_add_u32 s31, s77, 4096
    buffer_store_dwordx4 v[56:59], v3, s[20:23], s76 offen sc1
    buffer_store_dwordx4 v[60:63], v3, s[20:23], s30 offen sc1
    buffer_store_dwordx4 v[64:67], v3, s[20:23], s77 offen sc1
    buffer_store_dwordx4 v[68:71], v3, s[20:23], s31 offen sc1
    v_cmp_eq_u32 vcc, s84, v9
    v_cmp_eq_u32 s[28:29], s84, v141
    s_nop 1
    s_and_b64 vcc, vcc, s[28:29]
    s_cmp_eq_u64 vcc, -1
    s_cbranch_scc1 K_cs_ok
    s_mov_b32 s95, 0
SP_54:
    buffer_load_dwordx2 v[8:9], v34, s[20:23], s90 offen sc1
    buffer_load_dwordx2 v[140:141], v35, s[20:23], s75 offen sc1
    s_waitcnt vmcnt(0)
    v_cmp_eq_u32 vcc, s84, v9
    v_cmp_eq_u32 s[28:29], s84, v141
    s_nop 1
    s_and_b64 vcc, vcc, s[28:29]
    s_cmp_eq_u64 vcc, -1
    s_cbranch_scc1 SP_54_ok
    s_sleep 2
    s_add_u32 s95, s95, 1
    s_cmp_lt_u32 s95, 2097152
    s_cbranch_scc1 SP_54
SP_54_ok:
K_cs_ok:
    v_cmp_eq_u32 vcc, s74, v140
    s_lshl_b32 s30, s4, 8
    s_add_u32 s30, s30, 157696
    v_lshl_add_u32 v1, v0, 2, s30
    s_cmp_eq_u64 vcc, -1
    s_cselect_b32 s97, 2, 1
    v_mov_b32 v2, s97
    ds_write_b32 v1, v8
    ds_write_b32 v20, v2 offset:16
    v_lshrrev_b32 v14, 4, v0
    v_and_b32 v15, 15, v0
    v_bfe_u32 v10, v0, 1, 3
    v_xor_b32 v10, v10, v14
    v_lshlrev_b32 v10, 4, v10
    v_lshl_add_u32 v10, v15, 7, v10
    s_mul_i32 s30, s87, 24576
    s_add_u32 s30, s30, 32768
    v_add_u32 v10, s30, v10
    v_xor_b32 v11, 64, v10
    v_xor_b32 v12, 0x4000, v10
    v_xor_b32 v13, 0x4000, v11
    s_lshl_b32 s30, s91, 7
    s_lshl_b32 s31, s4, 2
    s_add_u32 s31, s31, s30
    v_mov_b32 v4, s31
    v_mov_b32 v5, s84
    s_waitcnt vmcnt(0)
    s_mov_b64 exec, 1
    s_cmp_eq_u32 s97, 2
    s_cbranch_scc1 DS_55_l
    buffer_store_dword v5, v4, s[20:23], s78 offen sc1
    s_branch DS_55_e
DS_55_l:
    buffer_store_dword v5, v4, s[20:23], s78 offen
DS_55_e:
    s_mov_b64 exec, -1
    s_lshl_b32 s92, s5, 1
    s_add_u32 s92, s92, s87
    s_mul_i32 s92, s92, 114688
    s_add_u32 s92, s92, 0
    s_lshl_b32 s30, s85, 13
    s_add_u32 s93, s92, s30
    s_add_u32 s93, s93, 49152
    s_lshl_b32 s30, s85, 16
    s_add_u32 s92, s92, s30
    v_and_b32 v8, 7, v0
    v_min_u32 v8, 6, v8
    v_lshlrev_b32 v8, 7, v8
    v_and_b32 v1, 8, v0
    v_add_u32 v8, v8, v1
    s_and_b32 s30, s4, 1
    s_lshl_b32 s31, s30, 2
    v_add_u32 v8, s31, v8
    s_lshl_b32 s30, s30, 10
    s_lshl_b32 s31, s85, 11
    s_add_u32 s30, s30, s31
    v_lshlrev_b32 v23, 12, v21
    v_and_b32 v14, 1, v14
    v_lshl_add_u32 v23, v14, 9, v23
    v_lshl_add_u32 v23, v15, 4, v23
    v_add_u32 v23, s30, v23
    v_xor_b32 v22, 0x800, v23
    s_mul_i32 s76, s5, 7
    s_add_u32 s76, s76, s91
    s_lshl_b32 s76, s76, 1
    s_add_u32 s76, s76, s85
    s_lshl_b32 s76, s76, 2
    s_add_u32 s76, s76, s4
    s_xor_b32 s77, s76, 4
    s_mul_i32 s77, s77, 3072
    s_add_u32 s77, s77, 11010048
    v_mov_b32 v56, v208
    v_mov_b32 v128, v216
    v_mov_b32 v57, v209
    v_mov_b32 v129, v217
    v_mov_b32 v58, v210
    v_mov_b32 v130, v218
    v_mov_b32 v59, v211
    v_mov_b32 v131, v219
    v_mov_b32 v60, v212
    v_mov_b32 v132, v220
    v_mov_b32 v61, v213
    v_mov_b32 v133, v221
    v_mov_b32 v62, v214
    v_mov_b32 v134, v222
    v_mov_b32 v63, v215
    v_mov_b32 v135, v223
    s_mov_b32 s95, 0
SP_56:
    ds_read_b128 v[4:7], v18
    s_waitcnt lgkmcnt(0)
    v_min_u32 v4, v4, v5
    v_min3_u32 v4, v4, v6, v7
    s_nop 0
    v_readfirstlane_b32 s82, v4
    s_cmp_ge_u32 s82, 6
    s_cbranch_scc1 SP_56_ok
    s_sleep 1
    s_add_u32 s95, s95, 1
    s_cmp_lt_u32 s95, 2097152
    s_cbranch_scc1 SP_56
SP_56_ok:
    ds_read_b128 v[144:147], v10 offset:0
    ds_read_b128 v[148:151], v10 offset:2048
    ds_read_b128 v[152:155], v12 offset:0
    ds_read_b128 v[156:159], v12 offset:2048
    ds_read_b128 v[160:163], v11 offset:0
    ds_read_b128 v[164:167], v11 offset:2048
    ds_read_b128 v[168:171], v13 offset:0
    ds_read_b128 v[172:175], v13 offset:2048
    ds_read_b128 v[176:179], v10 offset:4096
    ds_read_b128 v[180:183], v10 offset:6144
    ds_read_b128 v[184:187], v12 offset:4096
    ds_read_b128 v[188:191], v12 offset:6144
    ds_read_b128 v[192:195], v11 offset:4096
    ds_read_b128 v[196:199], v11 offset:6144
    ds_read_b128 v[200:203], v13 offset:4096
    ds_read_b128 v[204:207], v13 offset:6144
    s_waitcnt lgkmcnt(0)
    s_mov_b64 exec, 1
    ds_add_u32 v18, v19 offset:88
    s_mov_b64 exec, -1
    s_mov_b64 exec, 0xffff
    s_mov_b32 s95, 0
SP_57:
    buffer_load_dword v9, v8, s[20:23], s78 offen sc1
    s_waitcnt vmcnt(0)
    v_cmp_eq_u32 vcc, s84, v9
    s_nop 1
    s_cmp_eq_u64 vcc, exec
    s_cbranch_scc1 SP_57_ok
    s_sleep 4
    s_add_u32 s95, s95, 1
    s_cmp_lt_u32 s95, 2097152
    s_cbranch_scc1 SP_57
SP_57_ok:
    s_mov_b64 exec, -1
    buffer_load_dwordx4 v[24:27], v22, s[20:23], s92 offen offset:0 sc1
    buffer_load_dwordx4 v[28:31], v22, s[20:23], s92 offen offset:256 sc1
    buffer_load_dwordx4 v[32:35], v23, s[20:23], s92 offen offset:0 sc1
    buffer_load_dwordx4 v[36:39], v23, s[20:23], s92 offen offset:256 sc1
    s_add_u32 s92, s92, 8192
    buffer_load_dwordx4 v[40:43], v22, s[20:23], s92 offen offset:0 sc1
    buffer_load_dwordx4 v[44:47], v22, s[20:23], s92 offen offset:256 sc1
    buffer_load_dwordx4 v[48:51], v23, s[20:23], s92 offen offset:0 sc1
    s_mov_b32 s95, 0
SP_58:
    ds_read_b128 v[4:7], v18 offset:32
    s_waitcnt lgkmcnt(0)
    v_min_u32 v4, v4, v5
    v_min3_u32 v4, v4, v6, v7
    s_nop 0
    v_readfirstlane_b32 s82, v4
    s_cmp_lg_u32 s82, 0
    s_cbranch_scc1 SP_58_ok
    s_sleep 1
    s_add_u32 s95, s95, 1
    s_cmp_lt_u32 s95, 2097152
    s_cbranch_scc1 SP_58
SP_58_ok:
    s_setprio 3
    ds_read_b128 v[208:211], v10 offset:32768
    ds_read_b128 v[212:215], v10 offset:34816
    ds_read_b128 v[216:219], v12 offset:32768
    ds_read_b128 v[220:223], v12 offset:34816
    ds_read_b128 v[224:227], v11 offset:32768
    ds_read_b128 v[228:231], v11 offset:34816
    ds_read_b128 v[232:235], v13 offset:32768
    ds_read_b128 v[236:239], v13 offset:34816
    v_xor_b32 v10, s73, v10
    v_xor_b32 v12, s73, v12
    ds_read_b128 v[240:243], v10 offset:36864
    ds_read_b128 v[244:247], v10 offset:38912
    ds_read_b128 v[248:251], v12 offset:36864
    ds_read_b128 v[252:255], v12 offset:38912
    s_add_u32 s31, s89, 65536
    v_add_u32 v136, s31, v3
    v_xor_b32 v137, 0x2000, v136
    v_xor_b32 v138, 8, v20
    s_waitcnt vmcnt(6)
    v_mfma_f32_16x16x32_bf16 v[64:67], v[24:27], v[144:147], 0
    buffer_load_dwordx4 v[52:55], v23, s[20:23], s92 offen offset:256 sc1
    v_mfma_f32_16x16x32_bf16 v[72:75], v[24:27], v[148:151], 0
    v_mfma_f32_16x16x32_bf16 v[80:83], v[24:27], v[152:155], 0
    v_mfma_f32_16x16x32_bf16 v[88:91], v[24:27], v[156:159], 0
    s_waitcnt vmcnt(6)
    v_mfma_f32_16x16x32_bf16 v[68:71], v[28:31], v[144:147], 0
    s_add_u32 s92, s92, 8192
    buffer_load_dwordx4 v[24:27], v22, s[20:23], s92 offen offset:0 sc1
    v_mfma_f32_16x16x32_bf16 v[76:79], v[28:31], v[148:151], 0
    v_mfma_f32_16x16x32_bf16 v[84:87], v[28:31], v[152:155], 0
    v_mfma_f32_16x16x32_bf16 v[92:95], v[28:31], v[156:159], 0
    s_waitcnt vmcnt(6)
    v_mfma_f32_16x16x32_bf16 v[96:99], v[32:35], v[144:147], 0
    buffer_load_dwordx4 v[28:31], v22, s[20:23], s92 offen offset:256 sc1
    v_mfma_f32_16x16x32_bf16 v[104:107], v[32:35], v[148:151], 0
    v_mfma_f32_16x16x32_bf16 v[112:115], v[32:35], v[152:155], 0
    v_mfma_f32_16x16x32_bf16 v[120:123], v[32:35], v[156:159], 0
    s_waitcnt vmcnt(6)
    v_mfma_f32_16x16x32_bf16 v[100:103], v[36:39], v[144:147], 0
    buffer_load_dwordx4 v[32:35], v23, s[20:23], s92 offen offset:0 sc1
    v_mfma_f32_16x16x32_bf16 v[108:111], v[36:39], v[148:151], 0
    v_mfma_f32_16x16x32_bf16 v[116:119], v[36:39], v[152:155], 0
    v_mfma_f32_16x16x32_bf16 v[124:127], v[36:39], v[156:159], 0
    s_waitcnt vmcnt(6)
    v_mfma_f32_16x16x32_bf16 v[64:67], v[40:43], v[160:163], v[64:67]
    buffer_load_dwordx4 v[36:39], v23, s[20:23], s92 offen offset:256 sc1
    v_mfma_f32_16x16x32_bf16 v[72:75], v[40:43], v[164:167], v[72:75]
    v_mfma_f32_16x16x32_bf16 v[80:83], v[40:43], v[168:171], v[80:83]
    v_mfma_f32_16x16x32_bf16 v[88:91], v[40:43], v[172:175], v[88:91]
    s_waitcnt vmcnt(6)
    v_mfma_f32_16x16x32_bf16 v[68:71], v[44:47], v[160:163], v[68:71]
    s_add_u32 s92, s92, 8192
    buffer_load_dwordx4 v[40:43], v22, s[20:23], s92 offen offset:0 sc1
    v_mfma_f32_16x16x32_bf16 v[76:79], v[44:47], v[164:167], v[76:79]
    v_mfma_f32_16x16x32_bf16 v[84:87], v[44:47], v[168:171], v[84:87]
    v_mfma_f32_16x16x32_bf16 v[92:95], v[44:47], v[172:175], v[92:95]
    s_waitcnt vmcnt(6)
    v_mfma_f32_16x16x32_bf16 v[96:99], v[48:51], v[160:163], v[96:99]
    buffer_load_dwordx4 v[44:47], v22, s[20:23], s92 offen offset:256 sc1
    v_mfma_f32_16x16x32_bf16 v[104:107], v[48:51], v[164:167], v[104:107]
    v_mfma_f32_16x16x32_bf16 v[112:115], v[48:51], v[168:171], v[112:115]
    v_mfma_f32_16x16x32_bf16 v[120:123], v[48:51], v[172:175], v[120:123]
    s_waitcnt vmcnt(6)
    v_mfma_f32_16x16x32_bf16 v[100:103], v[52:55], v[160:163], v[100:103]
    buffer_load_dwordx4 v[48:51], v23, s[20:23], s92 offen offset:0 sc1
    v_mfma_f32_16x16x32_bf16 v[108:111], v[52:55], v[164:167], v[108:111]
    v_mfma_f32_16x16x32_bf16 v[116:119], v[52:55], v[168:171], v[116:119]
    v_mfma_f32_16x16x32_bf16 v[124:127], v[52:55], v[172:175], v[124:127]
    s_waitcnt lgkmcnt(0)
    s_mov_b64 exec, 1
    ds_add_u32 v18, v19 offset:92
    s_mov_b64 exec, -1
    s_waitcnt vmcnt(6)
    v_mfma_f32_16x16x32_bf16 v[64:67], v[24:27], v[176:179], v[64:67]
    buffer_load_dwordx4 v[52:55], v23, s[20:23], s92 offen offset:256 sc1
    v_mfma_f32_16x16x32_bf16 v[72:75], v[24:27], v[180:183], v[72:75]
    v_mfma_f32_16x16x32_bf16 v[80:83], v[24:27], v[184:187], v[80:83]
    v_mfma_f32_16x16x32_bf16 v[88:91], v[24:27], v[188:191], v[88:91]
    s_waitcnt vmcnt(6)
    v_mfma_f32_16x16x32_bf16 v[68:71], v[28:31], v[176:179], v[68:71]
    s_add_u32 s92, s92, 8192
    buffer_load_dwordx4 v[24:27], v22, s[20:23], s92 offen offset:0 sc1
    v_mfma_f32_16x16x32_bf16 v[76:79], v[28:31], v[180:183], v[76:79]
    v_mfma_f32_16x16x32_bf16 v[84:87], v[28:31], v[184:187], v[84:87]
    v_mfma_f32_16x16x32_bf16 v[92:95], v[28:31], v[188:191], v[92:95]
    s_waitcnt vmcnt(6)
    v_mfma_f32_16x16x32_bf16 v[96:99], v[32:35], v[176:179], v[96:99]
    buffer_load_dwordx4 v[28:31], v22, s[20:23], s92 offen offset:256 sc1
    v_mfma_f32_16x16x32_bf16 v[104:107], v[32:35], v[180:183], v[104:107]
    v_mfma_f32_16x16x32_bf16 v[112:115], v[32:35], v[184:187], v[112:115]
    v_mfma_f32_16x16x32_bf16 v[120:123], v[32:35], v[188:191], v[120:123]
    s_waitcnt vmcnt(6)
    v_mfma_f32_16x16x32_bf16 v[100:103], v[36:39], v[176:179], v[100:103]
    buffer_load_dwordx4 v[32:35], v23, s[20:23], s92 offen offset:0 sc1
    v_mfma_f32_16x16x32_bf16 v[108:111], v[36:39], v[180:183], v[108:111]
    v_mfma_f32_16x16x32_bf16 v[116:119], v[36:39], v[184:187], v[116:119]
    v_mfma_f32_16x16x32_bf16 v[124:127], v[36:39], v[188:191], v[124:127]
    s_waitcnt vmcnt(6)
    v_mfma_f32_16x16x32_bf16 v[64:67], v[40:43], v[192:195], v[64:67]
    buffer_load_dwordx4 v[36:39], v23, s[20:23], s92 offen offset:256 sc1
    v_mfma_f32_16x16x32_bf16 v[72:75], v[40:43], v[196:199], v[72:75]
    v_mfma_f32_16x16x32_bf16 v[80:83], v[40:43], v[200:203], v[80:83]
    v_mfma_f32_16x16x32_bf16 v[88:91], v[40:43], v[204:207], v[88:91]
    s_waitcnt vmcnt(6)
    v_mfma_f32_16x16x32_bf16 v[68:71], v[44:47], v[192:195], v[68:71]
    s_add_u32 s92, s92, 8192
    buffer_load_dwordx4 v[40:43], v22, s[20:23], s92 offen offset:0 sc1
    v_mfma_f32_16x16x32_bf16 v[76:79], v[44:47], v[196:199], v[76:79]
    v_mfma_f32_16x16x32_bf16 v[84:87], v[44:47], v[200:203], v[84:87]
    v_mfma_f32_16x16x32_bf16 v[92:95], v[44:47], v[204:207], v[92:95]
    s_waitcnt vmcnt(6)
    v_mfma_f32_16x16x32_bf16 v[96:99], v[48:51], v[192:195], v[96:99]
    buffer_load_dwordx4 v[44:47], v22, s[20:23], s92 offen offset:256 sc1
    v_mfma_f32_16x16x32_bf16 v[104:107], v[48:51], v[196:199], v[104:107]
    v_mfma_f32_16x16x32_bf16 v[112:115], v[48:51], v[200:203], v[112:115]
    v_mfma_f32_16x16x32_bf16 v[120:123], v[48:51], v[204:207], v[120:123]
    s_waitcnt vmcnt(6)
    v_mfma_f32_16x16x32_bf16 v[100:103], v[52:55], v[192:195], v[100:103]
    buffer_load_dwordx4 v[48:51], v23, s[20:23], s92 offen offset:0 sc1
    v_mfma_f32_16x16x32_bf16 v[108:111], v[52:55], v[196:199], v[108:111]
    v_mfma_f32_16x16x32_bf16 v[116:119], v[52:55], v[200:203], v[116:119]
    v_mfma_f32_16x16x32_bf16 v[124:127], v[52:55], v[204:207], v[124:127]
    s_waitcnt vmcnt(6)
    v_mfma_f32_16x16x32_bf16 v[64:67], v[24:27], v[208:211], v[64:67]
    buffer_load_dwordx4 v[52:55], v23, s[20:23], s92 offen offset:256 sc1
    v_mfma_f32_16x16x32_bf16 v[72:75], v[24:27], v[212:215], v[72:75]
    v_mfma_f32_16x16x32_bf16 v[80:83], v[24:27], v[216:219], v[80:83]
    v_mfma_f32_16x16x32_bf16 v[88:91], v[24:27], v[220:223], v[88:91]
    s_waitcnt vmcnt(6)
    v_mfma_f32_16x16x32_bf16 v[68:71], v[28:31], v[208:211], v[68:71]
    s_mov_b32 s92, s93
    buffer_load_dwordx4 v[24:27], v22, s[20:23], s92 offen offset:0 sc1
    v_mfma_f32_16x16x32_bf16 v[76:79], v[28:31], v[212:215], v[76:79]
    v_mfma_f32_16x16x32_bf16 v[84:87], v[28:31], v[216:219], v[84:87]
    v_mfma_f32_16x16x32_bf16 v[92:95], v[28:31], v[220:223], v[92:95]
    s_waitcnt vmcnt(6)
    v_mfma_f32_16x16x32_bf16 v[96:99], v[32:35], v[208:211], v[96:99]
    buffer_load_dwordx4 v[28:31], v22, s[20:23], s92 offen offset:256 sc1
    v_mfma_f32_16x16x32_bf16 v[104:107], v[32:35], v[212:215], v[104:107]
    v_mfma_f32_16x16x32_bf16 v[112:115], v[32:35], v[216:219], v[112:115]
    v_mfma_f32_16x16x32_bf16 v[120:123], v[32:35], v[220:223], v[120:123]
    s_waitcnt vmcnt(6)
    v_mfma_f32_16x16x32_bf16 v[100:103], v[36:39], v[208:211], v[100:103]
    buffer_load_dwordx4 v[32:35], v23, s[20:23], s92 offen offset:0 sc1
    v_mfma_f32_16x16x32_bf16 v[108:111], v[36:39], v[212:215], v[108:111]
    v_mfma_f32_16x16x32_bf16 v[116:119], v[36:39], v[216:219], v[116:119]
    v_mfma_f32_16x16x32_bf16 v[124:127], v[36:39], v[220:223], v[124:127]
    s_waitcnt vmcnt(6)
    v_mfma_f32_16x16x32_bf16 v[64:67], v[40:43], v[224:227], v[64:67]
    buffer_load_dwordx4 v[36:39], v23, s[20:23], s92 offen offset:256 sc1
    v_mfma_f32_16x16x32_bf16 v[72:75], v[40:43], v[228:231], v[72:75]
    v_mfma_f32_16x16x32_bf16 v[80:83], v[40:43], v[232:235], v[80:83]
    v_mfma_f32_16x16x32_bf16 v[88:91], v[40:43], v[236:239], v[88:91]
    s_waitcnt vmcnt(6)
    v_mfma_f32_16x16x32_bf16 v[68:71], v[44:47], v[224:227], v[68:71]
    v_mfma_f32_16x16x32_bf16 v[76:79], v[44:47], v[228:231], v[76:79]
    v_mfma_f32_16x16x32_bf16 v[84:87], v[44:47], v[232:235], v[84:87]
    v_mfma_f32_16x16x32_bf16 v[92:95], v[44:47], v[236:239], v[92:95]
    s_waitcnt vmcnt(5)
    v_mfma_f32_16x16x32_bf16 v[96:99], v[48:51], v[224:227], v[96:99]
    v_mfma_f32_16x16x32_bf16 v[104:107], v[48:51], v[228:231], v[104:107]
    v_mfma_f32_16x16x32_bf16 v[112:115], v[48:51], v[232:235], v[112:115]
    v_mfma_f32_16x16x32_bf16 v[120:123], v[48:51], v[236:239], v[120:123]
    s_waitcnt vmcnt(4)
    v_mfma_f32_16x16x32_bf16 v[100:103], v[52:55], v[224:227], v[100:103]
    v_mfma_f32_16x16x32_bf16 v[108:111], v[52:55], v[228:231], v[108:111]
    v_mfma_f32_16x16x32_bf16 v[116:119], v[52:55], v[232:235], v[116:119]
    v_mfma_f32_16x16x32_bf16 v[124:127], v[52:55], v[236:239], v[124:127]
    ds_read_b32 v1, v18 offset:92
    s_waitcnt vmcnt(3)
    v_mfma_f32_16x16x32_bf16 v[64:67], v[24:27], v[240:243], v[64:67]
    v_mfma_f32_16x16x32_bf16 v[72:75], v[24:27], v[244:247], v[72:75]
    v_mfma_f32_16x16x32_bf16 v[80:83], v[24:27], v[248:251], v[80:83]
    v_mfma_f32_16x16x32_bf16 v[88:91], v[24:27], v[252:255], v[88:91]
    s_waitcnt vmcnt(2)
    v_mfma_f32_16x16x32_bf16 v[68:71], v[28:31], v[240:243], v[68:71]
    v_mfma_f32_16x16x32_bf16 v[76:79], v[28:31], v[244:247], v[76:79]
    v_mfma_f32_16x16x32_bf16 v[84:87], v[28:31], v[248:251], v[84:87]
    v_mfma_f32_16x16x32_bf16 v[92:95], v[28:31], v[252:255], v[92:95]
    s_waitcnt vmcnt(1)
    v_mfma_f32_16x16x32_bf16 v[96:99], v[32:35], v[240:243], v[96:99]
    v_mfma_f32_16x16x32_bf16 v[104:107], v[32:35], v[244:247], v[104:107]
    v_mfma_f32_16x16x32_bf16 v[112:115], v[32:35], v[248:251], v[112:115]
    v_mfma_f32_16x16x32_bf16 v[120:123], v[32:35], v[252:255], v[120:123]
    s_waitcnt vmcnt(0)
    v_mfma_f32_16x16x32_bf16 v[100:103], v[36:39], v[240:243], v[100:103]
    v_mfma_f32_16x16x32_bf16 v[108:111], v[36:39], v[244:247], v[108:111]
    v_mfma_f32_16x16x32_bf16 v[116:119], v[36:39], v[248:251], v[116:119]
    v_mfma_f32_16x16x32_bf16 v[124:127], v[36:39], v[252:255], v[124:127]
    s_waitcnt lgkmcnt(0)
    v_readfirstlane_b32 s82, v1
    s_cmp_ge_u32 s82, 4
    s_cbranch_scc1 K_c1ok
    s_mov_b32 s95, 0
SP_59:
    ds_read_b32 v1, v18 offset:92
    s_waitcnt lgkmcnt(0)
    v_readfirstlane_b32 s82, v1
    s_cmp_ge_u32 s82, 4
    s_cbranch_scc1 SP_59_ok
    s_add_u32 s95, s95, 1
    s_cmp_lt_u32 s95, 2097152
    s_cbranch_scc1 SP_59
SP_59_ok:
K_c1ok:
    s_nop 5
    ds_write_b128 v136, v[80:83] offset:0
    ds_write_b128 v136, v[84:87] offset:1024
    ds_write_b128 v136, v[88:91] offset:2048
    ds_write_b128 v136, v[92:95] offset:3072
    ds_write_b128 v136, v[112:115] offset:16384
    ds_write_b128 v136, v[116:119] offset:17408
    ds_write_b128 v136, v[120:123] offset:18432
    ds_write_b128 v136, v[124:127] offset:19456
    ds_write_b32 v20, v19 offset:96
    s_mov_b32 s95, 0
SP_60:
    ds_read_b32 v1, v138 offset:96
    s_waitcnt lgkmcnt(0)
    v_readfirstlane_b32 s82, v1
    s_cmp_lg_u32 s82, 0
    s_cbranch_scc1 SP_60_ok
    s_add_u32 s95, s95, 1
    s_cmp_lt_u32 s95, 2097152
    s_cbranch_scc1 SP_60
SP_60_ok:
    ds_read_b128 v[80:83], v137 offset:0
    ds_read_b128 v[84:87], v137 offset:1024
    ds_read_b128 v[88:91], v137 offset:2048
    ds_read_b128 v[92:95], v137 offset:3072
    ds_read_b128 v[112:115], v137 offset:16384
    ds_read_b128 v[116:119], v137 offset:17408
    ds_read_b128 v[120:123], v137 offset:18432
    ds_read_b128 v[124:127], v137 offset:19456
    s_waitcnt lgkmcnt(4)
    v_add_f32 v64, v64, v80
    v_add_f32 v65, v65, v81
    v_add_f32 v66, v66, v82
    v_add_f32 v67, v67, v83
    v_add_f32 v68, v68, v84
    v_add_f32 v69, v69, v85
    v_add_f32 v70, v70, v86
    v_add_f32 v71, v71, v87
    v_add_f32 v72, v72, v88
    v_add_f32 v73, v73, v89
    v_add_f32 v74, v74, v90
    v_add_f32 v75, v75, v91
    v_add_f32 v76, v76, v92
    v_add_f32 v77, v77, v93
    v_add_f32 v78, v78, v94
    v_add_f32 v79, v79, v95
    v_cvt_pk_bf16_f32 v24, v64, v65
    v_cvt_pk_bf16_f32 v25, v66, v67
    v_cvt_pk_bf16_f32 v26, v68, v69
    v_cvt_pk_bf16_f32 v28, v70, v71
    v_cvt_pk_bf16_f32 v29, v72, v73
    v_cvt_pk_bf16_f32 v30, v74, v75
    v_cvt_pk_bf16_f32 v32, v76, v77
    v_cvt_pk_bf16_f32 v33, v78, v79
    v_mov_b32 v27, s84
    v_mov_b32 v31, s84
    v_mov_b32 v34, s84
    v_mov_b32 v35, s84
    s_waitcnt lgkmcnt(0)
    s_mov_b64 exec, 1
    ds_add_u32 v18, v19 offset:84
    s_mov_b64 exec, -1
    s_setprio 0
    buffer_store_dwordx4 v[24:27], v3, s[20:23], s77 offen offset:0 sc1
    v_add_f32 v96, v96, v112
    v_add_f32 v97, v97, v113
    v_add_f32 v98, v98, v114
    v_add_f32 v99, v99, v115
    v_add_f32 v100, v100, v116
    v_add_f32 v101, v101, v117
    v_add_f32 v102, v102, v118
    v_add_f32 v103, v103, v119
    v_add_f32 v104, v104, v120
    v_add_f32 v105, v105, v121
    v_add_f32 v106, v106, v122
    v_add_f32 v107, v107, v123
    v_add_f32 v108, v108, v124
    v_add_f32 v109, v109, v125
    v_add_f32 v110, v110, v126
    v_add_f32 v111, v111, v127
    v_lshlrev_b32 v112, 16, v128
    v_and_b32 v113, 0xffff0000, v128
    v_lshlrev_b32 v114, 16, v129
    v_and_b32 v115, 0xffff0000, v129
    v_lshlrev_b32 v116, 16, v130
    v_and_b32 v117, 0xffff0000, v130
    v_lshlrev_b32 v118, 16, v131
    v_and_b32 v119, 0xffff0000, v131
    v_lshlrev_b32 v120, 16, v132
    v_and_b32 v121, 0xffff0000, v132
    v_lshlrev_b32 v122, 16, v133
    v_and_b32 v123, 0xffff0000, v133
    v_lshlrev_b32 v124, 16, v134
    v_and_b32 v125, 0xffff0000, v134
    v_lshlrev_b32 v126, 16, v135
    v_and_b32 v127, 0xffff0000, v135
    buffer_store_dwordx4 v[28:31], v3, s[20:23], s77 offen offset:1024 sc1
    v_add_f32 v96, v96, v112
    v_add_f32 v97, v97, v113
    v_add_f32 v98, v98, v114
    v_add_f32 v99, v99, v115
    v_add_f32 v100, v100, v116
    v_add_f32 v101, v101, v117
    v_add_f32 v102, v102, v118
    v_add_f32 v103, v103, v119
    v_add_f32 v104, v104, v120
    v_add_f32 v105, v105, v121
    v_add_f32 v106, v106, v122
    v_add_f32 v107, v107, v123
    v_add_f32 v108, v108, v124
    v_add_f32 v109, v109, v125
    v_add_f32 v110, v110, v126
    v_add_f32 v111, v111, v127
    s_mov_b32 s95, 0
SP_61:
    ds_read_b32 v1, v18 offset:84
    s_waitcnt lgkmcnt(0)
    v_readfirstlane_b32 s82, v1
    s_cmp_ge_u32 s82, 4
    s_cbranch_scc1 SP_61_ok
    s_sleep 1
    s_add_u32 s95, s95, 1
    s_cmp_lt_u32 s95, 2097152
    s_cbranch_scc1 SP_61
SP_61_ok:
    ds_write_b128 v136, v[96:99] offset:0
    ds_write_b128 v136, v[100:103] offset:1024
    ds_write_b128 v136, v[104:107] offset:2048
    ds_write_b128 v136, v[108:111] offset:3072
    s_sub_u32 s31, s79, 16384
    v_add_u32 v11, s31, v3
    ds_write_b128 v11, v[56:59] offset:0
    ds_write_b128 v11, v[60:63] offset:1024
    ds_write_b32 v20, v19 offset:128
    s_waitcnt lgkmcnt(0)
    buffer_store_dwordx4 v[32:35], v3, s[20:23], s77 offen offset:2048 sc1
    s_waitcnt lgkmcnt(0)
    s_barrier
    s_endpgm
K_SPARE:
    s_cmp_ge_u32 s2, 252
    s_cbranch_scc1 K_END
    v_mov_b32 v2, v0
    v_and_b32 v0, 63, v0
    s_lshr_b32 s3, s3, 6
    v_lshlrev_b32 v7, 7, v2
    s_sub_u32 s4, s2, 224
    s_lshr_b32 s5, s4, 1
    s_and_b32 s6, s4, 1
    v_lshrrev_b32 v3, 4, v2
    v_and_b32 v4, 15, v2
    v_mul_u32_u24 v5, 0xe00, v3
    v_lshl_add_u32 v5, v4, 4, v5
    v_mov_b32 v6, 0
    s_mov_b32 s82, 18591744
    s_lshl_b32 s28, s5, 8
    s_cmp_eq_u32 s6, 0
    s_waitcnt lgkmcnt(0)
    s_cselect_b32 s16, s52, s54
    s_cselect_b32 s17, s53, s55
    s_and_b32 s17, s17, 0xffff
    s_mov_b32 s18, 1605632
    s_mov_b32 s19, 0x20000
    s_mov_b32 s20, s62
    s_and_b32 s21, s63, 0xffff
    s_mov_b32 s22, 18591872
    s_mov_b32 s23, 0x20000
    s_mov_b32 s8, s56
    s_and_b32 s9, s57, 0xffff
    s_mov_b32 s10, 1605632
    s_mov_b32 s11, 0x20000
    s_mov_b32 s64, s42
    s_and_b32 s65, s43, 0xffff
    s_mov_b32 s66, 401408
    s_mov_b32 s67, 0x20000
    s_mov_b32 s68, s44
    s_and_b32 s69, s45, 0xffff
    s_mov_b32 s70, 401408
    s_mov_b32 s71, 0x20000
    s_cmp_ge_u32 s4, 28
    s_cbranch_scc1 K_sp4
    buffer_load_dword v6, v6, s[20:23], s82 offen sc1
    s_waitcnt vmcnt(0)
    buffer_load_dwordx4 v[16:19], v5, s[16:19], s28 offen
    s_add_u32 s28, s28, 114688
    buffer_load_dwordx4 v[20:23], v5, s[16:19], s28 offen
    s_add_u32 s28, s28, 114688
    buffer_load_dwordx4 v[24:27], v5, s[16:19], s28 offen
    s_add_u32 s28, s28, 114688
    buffer_load_dwordx4 v[28:31], v5, s[16:19], s28 offen
    s_add_u32 s28, s28, 114688
    buffer_load_dwordx4 v[32:35], v5, s[16:19], s28 offen
    s_add_u32 s28, s28, 114688
    buffer_load_dwordx4 v[36:39], v5, s[16:19], s28 offen
    s_add_u32 s28, s28, 114688
    buffer_load_dwordx4 v[40:43], v5, s[16:19], s28 offen
    s_add_u32 s28, s28, 114688
    buffer_load_dwordx4 v[44:47], v5, s[16:19], s28 offen
    s_add_u32 s28, s28, 114688
    buffer_load_dwordx4 v[48:51], v5, s[16:19], s28 offen
    s_add_u32 s28, s28, 114688
    buffer_load_dwordx4 v[52:55], v5, s[16:19], s28 offen
    s_add_u32 s28, s28, 114688
    buffer_load_dwordx4 v[56:59], v5, s[16:19], s28 offen
    s_add_u32 s28, s28, 114688
    buffer_load_dwordx4 v[60:63], v5, s[16:19], s28 offen
    s_add_u32 s28, s28, 114688
    buffer_load_dwordx4 v[64:67], v5, s[16:19], s28 offen
    s_add_u32 s28, s28, 114688
    buffer_load_dwordx4 v[68:71], v5, s[16:19], s28 offen
    v_mov_b32 v8, 0
    v_mov_b32 v9, 0
    v_mov_b32 v10, 0
    v_mov_b32 v11, 0
    v_mov_b32 v12, 0
    v_mov_b32 v13, 0
    v_mov_b32 v14, 0
    v_mov_b32 v15, 0
    s_waitcnt vmcnt(13)
    v_lshlrev_b32 v72, 16, v16
    v_and_b32 v73, 0xffff0000, v16
    v_pk_add_f32 v[8:9], v[8:9], v[72:73]
    v_lshlrev_b32 v72, 16, v17
    v_and_b32 v73, 0xffff0000, v17
    v_pk_add_f32 v[10:11], v[10:11], v[72:73]
    v_lshlrev_b32 v72, 16, v18
    v_and_b32 v73, 0xffff0000, v18
    v_pk_add_f32 v[12:13], v[12:13], v[72:73]
    v_lshlrev_b32 v72, 16, v19
    v_and_b32 v73, 0xffff0000, v19
    v_pk_add_f32 v[14:15], v[14:15], v[72:73]
    s_waitcnt vmcnt(12)
    v_lshlrev_b32 v72, 16, v20
    v_and_b32 v73, 0xffff0000, v20
    v_pk_add_f32 v[8:9], v[8:9], v[72:73]
    v_lshlrev_b32 v72, 16, v21
    v_and_b32 v73, 0xffff0000, v21
    v_pk_add_f32 v[10:11], v[10:11], v[72:73]
    v_lshlrev_b32 v72, 16, v22
    v_and_b32 v73, 0xffff0000, v22
    v_pk_add_f32 v[12:13], v[12:13], v[72:73]
    v_lshlrev_b32 v72, 16, v23
    v_and_b32 v73, 0xffff0000, v23
    v_pk_add_f32 v[14:15], v[14:15], v[72:73]
    s_waitcnt vmcnt(11)
    v_lshlrev_b32 v72, 16, v24
    v_and_b32 v73, 0xffff0000, v24
    v_pk_add_f32 v[8:9], v[8:9], v[72:73]
    v_lshlrev_b32 v72, 16, v25
    v_and_b32 v73, 0xffff0000, v25
    v_pk_add_f32 v[10:11], v[10:11], v[72:73]
    v_lshlrev_b32 v72, 16, v26
    v_and_b32 v73, 0xffff0000, v26
    v_pk_add_f32 v[12:13], v[12:13], v[72:73]
    v_lshlrev_b32 v72, 16, v27
    v_and_b32 v73, 0xffff0000, v27
    v_pk_add_f32 v[14:15], v[14:15], v[72:73]
    s_waitcnt vmcnt(10)
    v_lshlrev_b32 v72, 16, v28
    v_and_b32 v73, 0xffff0000, v28
    v_pk_add_f32 v[8:9], v[8:9], v[72:73]
    v_lshlrev_b32 v72, 16, v29
    v_and_b32 v73, 0xffff0000, v29
    v_pk_add_f32 v[10:11], v[10:11], v[72:73]
    v_lshlrev_b32 v72, 16, v30
    v_and_b32 v73, 0xffff0000, v30
    v_pk_add_f32 v[12:13], v[12:13], v[72:73]
    v_lshlrev_b32 v72, 16, v31
    v_and_b32 v73, 0xffff0000, v31
    v_pk_add_f32 v[14:15], v[14:15], v[72:73]
    s_waitcnt vmcnt(9)
    v_lshlrev_b32 v72, 16, v32
    v_and_b32 v73, 0xffff0000, v32
    v_pk_add_f32 v[8:9], v[8:9], v[72:73]
    v_lshlrev_b32 v72, 16, v33
    v_and_b32 v73, 0xffff0000, v33
    v_pk_add_f32 v[10:11], v[10:11], v[72:73]
    v_lshlrev_b32 v72, 16, v34
    v_and_b32 v73, 0xffff0000, v34
    v_pk_add_f32 v[12:13], v[12:13], v[72:73]
    v_lshlrev_b32 v72, 16, v35
    v_and_b32 v73, 0xffff0000, v35
    v_pk_add_f32 v[14:15], v[14:15], v[72:73]
    s_waitcnt vmcnt(8)
    v_lshlrev_b32 v72, 16, v36
    v_and_b32 v73, 0xffff0000, v36
    v_pk_add_f32 v[8:9], v[8:9], v[72:73]
    v_lshlrev_b32 v72, 16, v37
    v_and_b32 v73, 0xffff0000, v37
    v_pk_add_f32 v[10:11], v[10:11], v[72:73]
    v_lshlrev_b32 v72, 16, v38
    v_and_b32 v73, 0xffff0000, v38
    v_pk_add_f32 v[12:13], v[12:13], v[72:73]
    v_lshlrev_b32 v72, 16, v39
    v_and_b32 v73, 0xffff0000, v39
    v_pk_add_f32 v[14:15], v[14:15], v[72:73]
    s_waitcnt vmcnt(7)
    v_lshlrev_b32 v72, 16, v40
    v_and_b32 v73, 0xffff0000, v40
    v_pk_add_f32 v[8:9], v[8:9], v[72:73]
    v_lshlrev_b32 v72, 16, v41
    v_and_b32 v73, 0xffff0000, v41
    v_pk_add_f32 v[10:11], v[10:11], v[72:73]
    v_lshlrev_b32 v72, 16, v42
    v_and_b32 v73, 0xffff0000, v42
    v_pk_add_f32 v[12:13], v[12:13], v[72:73]
    v_lshlrev_b32 v72, 16, v43
    v_and_b32 v73, 0xffff0000, v43
    v_pk_add_f32 v[14:15], v[14:15], v[72:73]
    s_waitcnt vmcnt(6)
    v_lshlrev_b32 v72, 16, v44
    v_and_b32 v73, 0xffff0000, v44
    v_pk_add_f32 v[8:9], v[8:9], v[72:73]
    v_lshlrev_b32 v72, 16, v45
    v_and_b32 v73, 0xffff0000, v45
    v_pk_add_f32 v[10:11], v[10:11], v[72:73]
    v_lshlrev_b32 v72, 16, v46
    v_and_b32 v73, 0xffff0000, v46
    v_pk_add_f32 v[12:13], v[12:13], v[72:73]
    v_lshlrev_b32 v72, 16, v47
    v_and_b32 v73, 0xffff0000, v47
    v_pk_add_f32 v[14:15], v[14:15], v[72:73]
    s_waitcnt vmcnt(5)
    v_lshlrev_b32 v72, 16, v48
    v_and_b32 v73, 0xffff0000, v48
    v_pk_add_f32 v[8:9], v[8:9], v[72:73]
    v_lshlrev_b32 v72, 16, v49
    v_and_b32 v73, 0xffff0000, v49
    v_pk_add_f32 v[10:11], v[10:11], v[72:73]
    v_lshlrev_b32 v72, 16, v50
    v_and_b32 v73, 0xffff0000, v50
    v_pk_add_f32 v[12:13], v[12:13], v[72:73]
    v_lshlrev_b32 v72, 16, v51
    v_and_b32 v73, 0xffff0000, v51
    v_pk_add_f32 v[14:15], v[14:15], v[72:73]
    s_waitcnt vmcnt(4)
    v_lshlrev_b32 v72, 16, v52
    v_and_b32 v73, 0xffff0000, v52
    v_pk_add_f32 v[8:9], v[8:9], v[72:73]
    v_lshlrev_b32 v72, 16, v53
    v_and_b32 v73, 0xffff0000, v53
    v_pk_add_f32 v[10:11], v[10:11], v[72:73]
    v_lshlrev_b32 v72, 16, v54
    v_and_b32 v73, 0xffff0000, v54
    v_pk_add_f32 v[12:13], v[12:13], v[72:73]
    v_lshlrev_b32 v72, 16, v55
    v_and_b32 v73, 0xffff0000, v55
    v_pk_add_f32 v[14:15], v[14:15], v[72:73]
    s_waitcnt vmcnt(3)
    v_lshlrev_b32 v72, 16, v56
    v_and_b32 v73, 0xffff0000, v56
    v_pk_add_f32 v[8:9], v[8:9], v[72:73]
    v_lshlrev_b32 v72, 16, v57
    v_and_b32 v73, 0xffff0000, v57
    v_pk_add_f32 v[10:11], v[10:11], v[72:73]
    v_lshlrev_b32 v72, 16, v58
    v_and_b32 v73, 0xffff0000, v58
    v_pk_add_f32 v[12:13], v[12:13], v[72:73]
    v_lshlrev_b32 v72, 16, v59
    v_and_b32 v73, 0xffff0000, v59
    v_pk_add_f32 v[14:15], v[14:15], v[72:73]
    s_waitcnt vmcnt(2)
    v_lshlrev_b32 v72, 16, v60
    v_and_b32 v73, 0xffff0000, v60
    v_pk_add_f32 v[8:9], v[8:9], v[72:73]
    v_lshlrev_b32 v72, 16, v61
    v_and_b32 v73, 0xffff0000, v61
    v_pk_add_f32 v[10:11], v[10:11], v[72:73]
    v_lshlrev_b32 v72, 16, v62
    v_and_b32 v73, 0xffff0000, v62
    v_pk_add_f32 v[12:13], v[12:13], v[72:73]
    v_lshlrev_b32 v72, 16, v63
    v_and_b32 v73, 0xffff0000, v63
    v_pk_add_f32 v[14:15], v[14:15], v[72:73]
    s_waitcnt vmcnt(1)
    v_lshlrev_b32 v72, 16, v64
    v_and_b32 v73, 0xffff0000, v64
    v_pk_add_f32 v[8:9], v[8:9], v[72:73]
    v_lshlrev_b32 v72, 16, v65
    v_and_b32 v73, 0xffff0000, v65
    v_pk_add_f32 v[10:11], v[10:11], v[72:73]
    v_lshlrev_b32 v72, 16, v66
    v_and_b32 v73, 0xffff0000, v66
    v_pk_add_f32 v[12:13], v[12:13], v[72:73]
    v_lshlrev_b32 v72, 16, v67
    v_and_b32 v73, 0xffff0000, v67
    v_pk_add_f32 v[14:15], v[14:15], v[72:73]
    s_waitcnt vmcnt(0)
    v_lshlrev_b32 v72, 16, v68
    v_and_b32 v73, 0xffff0000, v68
    v_pk_add_f32 v[8:9], v[8:9], v[72:73]
    v_lshlrev_b32 v72, 16, v69
    v_and_b32 v73, 0xffff0000, v69
    v_pk_add_f32 v[10:11], v[10:11], v[72:73]
    v_lshlrev_b32 v72, 16, v70
    v_and_b32 v73, 0xffff0000, v70
    v_pk_add_f32 v[12:13], v[12:13], v[72:73]
    v_lshlrev_b32 v72, 16, v71
    v_and_b32 v73, 0xffff0000, v71
    v_pk_add_f32 v[14:15], v[14:15], v[72:73]
    v_lshlrev_b32 v3, 5, v2
    ds_write_b128 v3, v[8:11]
    ds_write_b128 v3, v[12:15] offset:16
    s_waitcnt lgkmcnt(0)
    s_barrier
    s_cmp_lg_u32 s3, 7
    s_cbranch_scc1 K_sp2
    v_lshlrev_b32 v3, 3, v0
    v_add_u32 v9, 1, v6
    v_max_u32 v9, 1, v9
    v_mov_b32 v11, v9
    ds_read_b64 v[16:17], v3 offset:0
    ds_read_b64 v[18:19], v3 offset:512
    ds_read_b64 v[20:21], v3 offset:1024
    ds_read_b64 v[22:23], v3 offset:1536
    ds_read_b64 v[24:25], v3 offset:2048
    ds_read_b64 v[26:27], v3 offset:2560
    ds_read_b64 v[28:29], v3 offset:3072
    ds_read_b64 v[30:31], v3 offset:3584
    ds_read_b64 v[32:33], v3 offset:4096
    ds_read_b64 v[34:35], v3 offset:4608
    ds_read_b64 v[36:37], v3 offset:5120
    ds_read_b64 v[38:39], v3 offset:5632
    ds_read_b64 v[40:41], v3 offset:6144
    ds_read_b64 v[42:43], v3 offset:6656
    ds_read_b64 v[44:45], v3 offset:7168
    ds_read_b64 v[46:47], v3 offset:7680
    s_waitcnt lgkmcnt(0)
    v_mov_b32 v12, 0
    v_mov_b32 v13, 0
    v_pk_add_f32 v[12:13], v[12:13], v[16:17]
    v_pk_add_f32 v[12:13], v[12:13], v[18:19]
    v_pk_add_f32 v[12:13], v[12:13], v[20:21]
    v_pk_add_f32 v[12:13], v[12:13], v[22:23]
    v_pk_add_f32 v[12:13], v[12:13], v[24:25]
    v_pk_add_f32 v[12:13], v[12:13], v[26:27]
    v_pk_add_f32 v[12:13], v[12:13], v[28:29]
    v_pk_add_f32 v[12:13], v[12:13], v[30:31]
    v_pk_add_f32 v[12:13], v[12:13], v[32:33]
    v_pk_add_f32 v[12:13], v[12:13], v[34:35]
    v_pk_add_f32 v[12:13], v[12:13], v[36:37]
    v_pk_add_f32 v[12:13], v[12:13], v[38:39]
    v_pk_add_f32 v[12:13], v[12:13], v[40:41]
    v_pk_add_f32 v[12:13], v[12:13], v[42:43]
    v_pk_add_f32 v[12:13], v[12:13], v[44:45]
    v_pk_add_f32 v[12:13], v[12:13], v[46:47]
    ds_read_b64 v[16:17], v3 offset:8192
    ds_read_b64 v[18:19], v3 offset:8704
    ds_read_b64 v[20:21], v3 offset:9216
    ds_read_b64 v[22:23], v3 offset:9728
    ds_read_b64 v[24:25], v3 offset:10240
    ds_read_b64 v[26:27], v3 offset:10752
    ds_read_b64 v[28:29], v3 offset:11264
    ds_read_b64 v[30:31], v3 offset:11776
    ds_read_b64 v[32:33], v3 offset:12288
    ds_read_b64 v[34:35], v3 offset:12800
    ds_read_b64 v[36:37], v3 offset:13312
    ds_read_b64 v[38:39], v3 offset:13824
    ds_read_b64 v[40:41], v3 offset:14336
    ds_read_b64 v[42:43], v3 offset:14848
    ds_read_b64 v[44:45], v3 offset:15360
    ds_read_b64 v[46:47], v3 offset:15872
    s_waitcnt lgkmcnt(0)
    v_pk_add_f32 v[12:13], v[12:13], v[16:17]
    v_pk_add_f32 v[12:13], v[12:13], v[18:19]
    v_pk_add_f32 v[12:13], v[12:13], v[20:21]
    v_pk_add_f32 v[12:13], v[12:13], v[22:23]
    v_pk_add_f32 v[12:13], v[12:13], v[24:25]
    v_pk_add_f32 v[12:13], v[12:13], v[26:27]
    v_pk_add_f32 v[12:13], v[12:13], v[28:29]
    v_pk_add_f32 v[12:13], v[12:13], v[30:31]
    v_pk_add_f32 v[12:13], v[12:13], v[32:33]
    v_pk_add_f32 v[12:13], v[12:13], v[34:35]
    v_pk_add_f32 v[12:13], v[12:13], v[36:37]
    v_pk_add_f32 v[12:13], v[12:13], v[38:39]
    v_pk_add_f32 v[12:13], v[12:13], v[40:41]
    v_pk_add_f32 v[12:13], v[12:13], v[42:43]
    v_pk_add_f32 v[12:13], v[12:13], v[44:45]
    v_pk_add_f32 v[12:13], v[12:13], v[46:47]
    v_mov_b32 v8, v12
    v_mov_b32 v10, v13
    v_lshlrev_b32 v3, 4, v0
    s_lshl_b32 s30, s4, 10
    s_add_u32 s30, s30, 18464768
    buffer_store_dwordx4 v[8:11], v3, s[20:23], s30 offen sc1
K_sp2:
    s_mul_i32 s28, s4, 57344
    s_mul_i32 s29, s4, 14336
    buffer_load_dword v80, v7, s[8:11], s28 offen
    v_and_b32 v4, 0x3fff, v7
    s_cmp_lt_u32 s3, 2
    s_cselect_b32 s64, s64, s68
    s_cselect_b32 s65, s65, s69
    s_cmp_lt_u32 s3, 4
    s_cselect_b32 s66, s66, 0
    buffer_load_dword v81, v4, s[64:67], s29 offen
K_sp4:
K_sp3:
K_END:
    s_endpgm
ALL_END:

.section .rodata,"a"
.p2align 6
.amdhsa_kernel recurrent_scan__ssm_conv_s5__glu_gated_reglu__prompt_kernel
  .amdhsa_next_free_vgpr 256
  .amdhsa_next_free_sgpr 102
  .amdhsa_accum_offset 256
  .amdhsa_group_segment_fixed_size 0
  .amdhsa_kernarg_size 128
  .amdhsa_user_sgpr_count 2
  .amdhsa_user_sgpr_kernarg_segment_ptr 1
  .amdhsa_system_sgpr_workgroup_id_x 1
  .amdhsa_float_denorm_mode_32 3
.end_amdhsa_kernel
```
